```python
import torch

def _softmax(x, axis=-1):
    return torch.softmax(x, dim=axis)
def _gelu(x):
    return torch.nn.functional.gelu(x, approximate="tanh")
def _silu(x):
    return torch.nn.functional.silu(x)
def _sigmoid(x):
    return torch.sigmoid(x)
def _layernorm(x, axis=-1, eps=1e-5):
    m = x.mean(dim=axis, keepdim=True)
    v = x.var(dim=axis, keepdim=True, unbiased=False)
    return (x - m) / torch.sqrt(v + eps)
def _scatter_add(tgt, idx, src, axis=0):
    return tgt.clone().index_add_(axis, idx, src)
def _segment_sum(src, seg, n):
    out = torch.zeros((n,) + src.shape[1:], dtype=src.dtype)
    return out.index_add_(0, seg, src)
def _pad(x, pw):
    flat = tuple(v for pair in reversed(pw) for v in pair)
    return torch.nn.functional.pad(x, flat)

kernel_name = 'standalone__paged_block_table_kv_pagedattention__prompt'

def setup_inputs():

    _w = (lambda a: (lambda t: t.to(torch.bfloat16) if t.is_floating_point() else t)(torch.as_tensor(a)))
    B, Hq, Hkv, Sq, Skv, D = 1, 16, 8, 2048, 2048, 256
    bs = 16
    nbps = max(1, Skv // bs)
    num_phys = B * nbps + 4
    bt = torch.randperm(num_phys)[: B * nbps].reshape(B, nbps).to(torch.int64)
    cl = (nbps * bs - (torch.arange(1, B + 1, dtype=torch.int64) * 2654435761) % max(1, nbps * bs // 2)).to(torch.int64)
    return {
        "q": _w((lambda *s: torch.randn(*s, dtype=torch.bfloat16) * 0.8)(B, Hq, Sq, D)),
        "k_cache": _w((lambda *s: torch.randn(*s, dtype=torch.bfloat16) * 0.8)(num_phys, bs, Hkv, D)),
        "v_cache": _w((lambda *s: torch.randn(*s, dtype=torch.bfloat16) * 0.05)(num_phys, bs, Hkv, D)),
        "block_table": _w(bt),
        "context_lens": _w(cl),
    }

def reference(q, k_cache, v_cache, block_table, context_lens):
    B, Hq, Sq, D = q.shape
    bs = k_cache.shape[1]
    Hkv = k_cache.shape[2]
    nbps = block_table.shape[1]
    Skv = nbps * bs
    bt = block_table.reshape(-1)
    k = (lambda x, *d: x.permute(*d))(k_cache[bt].reshape(B, Skv, Hkv, D), 0, 2, 1, 3)
    v = (lambda x, *d: x.permute(*d))(v_cache[bt].reshape(B, Skv, Hkv, D), 0, 2, 1, 3)
    g = Hq // Hkv
    qg = q.reshape(B, Hkv, g, Sq, D)
    scores = torch.einsum("bhgqd,bhkd->bhgqk", qg, k) * (D ** -0.5)
    pos = torch.arange(Skv)
    msk = pos[None, :] < context_lens[:, None]
    scores = torch.where(msk[:, None, None, None, :], scores, -1e9)
    p = _softmax(scores, axis=-1)
    out = torch.einsum("bhgqk,bhkd->bhgqd", p, v)
    return out.reshape(B, Hq, Sq, D)
```

```asm
; @launch grid=(256,1,1) block=(256,1,1) lds=137216
.amdgcn_target "amdgcn-amd-amdhsa--gfx950"
.text
.globl standalone__paged_block_table_kv_pagedattention__prompt_kernel
.p2align 8
.type standalone__paged_block_table_kv_pagedattention__prompt_kernel,@function
standalone__paged_block_table_kv_pagedattention__prompt_kernel:
    s_cmp_ge_u32 s2, 256
    s_cbranch_scc1 L_end
    s_load_dwordx8 s[4:11], s[0:1], 0
    s_load_dwordx4 s[12:15], s[0:1], 32
    s_getpc_b64 s[98:99]
    v_lshlrev_b32 v120, 6, v0
    global_load_dword v124, v120, s[98:99] offset:0
    v_lshrrev_b32 v100, 6, v0
    v_and_b32 v95, 63, v0
    v_readfirstlane_b32 s43, v100
    s_and_b32 s44, s2, 7
    s_lshr_b32 s45, s2, 3
    v_lshrrev_b32 v101, 4, v95
    v_and_b32 v102, 15, v95
    v_lshlrev_b32 v103, 9, v102
    v_lshl_add_u32 v93, v101, 4, v103
    s_lshl_b32 s56, s44, 12
    s_lshl_b32 s57, s45, 7
    s_add_u32 s56, s56, s57
    s_lshl_b32 s57, s43, 5
    s_add_u32 s56, s56, s57
    s_lshl_b32 s54, s56, 9
    s_add_u32 s55, s54, 8192
    s_lshr_b32 s58, s43, 1
    v_lshl_add_u32 v104, v95, 1, s58
    v_lshlrev_b32 v105, 2, v104
    s_lshl_b32 s59, s58, 2
    v_lshrrev_b32 v106, 5, v95
    v_and_b32 v107, 31, v95
    v_xor_b32 v103, v107, v106
    v_lshlrev_b32 v103, 4, v103
    v_lshl_add_u32 v84, v106, 12, v103
    v_lshlrev_b32 v108, 1, v106
    v_xor_b32 v103, v107, v108
    v_lshlrev_b32 v103, 4, v103
    v_lshl_add_u32 v88, v106, 12, v103
    v_add_u32 v85, 7136, v84
    v_add_u32 v89, 7104, v88
    v_add_u32 v86, 14272, v84
    v_add_u32 v90, 14208, v88
    v_add_u32 v87, 21408, v84
    v_add_u32 v91, 21312, v88
    s_mul_i32 s46, s43, 4224
    s_mul_i32 s47, s43, 4352
    s_add_u32 s47, s47, 67584
    s_lshl_b32 s57, s44, 9
    s_and_b32 s60, s43, 1
    s_lshl_b32 s60, s60, 15
    s_add_u32 s57, s57, s60
    s_waitcnt lgkmcnt(0)
    s_load_dword s40, s[12:13], 0
    s_add_u32 s74, s10, s59
    s_addc_u32 s75, s11, 0
    s_load_dwordx8 s[64:71], s[74:75], 0
    s_load_dword s72, s[74:75], 32
    s_mov_b32 s20, s4
    s_and_b32 s21, s5, 65535
    s_mov_b32 s22, 16777216
    s_mov_b32 s23, 131072
    buffer_load_dwordx4 v[0:3], v93, s[20:23], s54 offen
    buffer_load_dwordx4 v[8:11], v93, s[20:23], s54 offen offset:64
    buffer_load_dwordx4 v[4:7], v93, s[20:23], s55 offen
    buffer_load_dwordx4 v[12:15], v93, s[20:23], s55 offen offset:64
    buffer_load_dwordx4 v[16:19], v93, s[20:23], s54 offen offset:128
    buffer_load_dwordx4 v[24:27], v93, s[20:23], s54 offen offset:192
    buffer_load_dwordx4 v[20:23], v93, s[20:23], s55 offen offset:128
    buffer_load_dwordx4 v[28:31], v93, s[20:23], s55 offen offset:192
    s_mov_b32 s24, s6
    s_and_b32 s25, s7, 65535
    s_mov_b32 s26, 8650752
    s_mov_b32 s27, 131072
    s_mov_b32 s28, s8
    s_and_b32 s29, s9, 65535
    s_mov_b32 s30, 8650752
    s_mov_b32 s31, 131072
    s_mov_b32 s36, s10
    s_and_b32 s37, s11, 65535
    s_mov_b32 s38, 512
    s_mov_b32 s39, 131072
    s_waitcnt lgkmcnt(0)
    s_cmp_lt_i32 s40, 1
    s_cselect_b32 s48, 0, 0x3db8aa3b
    s_cselect_b32 s49, 0, 0x3db8aa3b
    s_cselect_b32 s40, 2048, s40
    s_min_i32 s40, s40, 2048
    s_add_u32 s56, s40, 15
    s_lshr_b32 s56, s56, 4
    s_sub_u32 s60, s56, s58
    s_lshl_b32 s61, s64, 16
    s_add_u32 s61, s61, s57
    s_cmp_gt_i32 s60, 0
    s_cselect_b32 s61, s61, 0x40000000
    s_lshl_b32 s81, s66, 16
    s_add_u32 s81, s81, s57
    s_cmp_gt_i32 s60, 2
    s_cselect_b32 s81, s81, 0x40000000
    s_lshl_b32 s82, s68, 16
    s_add_u32 s82, s82, s57
    s_cmp_gt_i32 s60, 4
    s_cselect_b32 s82, s82, 0x40000000
    s_lshl_b32 s83, s70, 16
    s_add_u32 s83, s83, s57
    s_cmp_gt_i32 s60, 6
    s_cselect_b32 s83, s83, 0x40000000
    s_lshl_b32 s80, s72, 16
    s_add_u32 s80, s80, s57
    s_cmp_gt_i32 s60, 8
    s_cselect_b32 s80, s80, 0x40000000
    s_add_u32 m0, s46, 0
    s_nop 0
    buffer_load_dwordx4 v84, s[24:27], s61 offen lds
    buffer_load_dwordx4 v85, s[24:27], s61 offen offset:1056 lds
    buffer_load_dwordx4 v86, s[24:27], s61 offen offset:2112 lds
    buffer_load_dwordx4 v87, s[24:27], s61 offen offset:3168 lds
    s_add_u32 m0, s46, 16896
    s_nop 0
    buffer_load_dwordx4 v84, s[24:27], s81 offen lds
    buffer_load_dwordx4 v85, s[24:27], s81 offen offset:1056 lds
    buffer_load_dwordx4 v86, s[24:27], s81 offen offset:2112 lds
    buffer_load_dwordx4 v87, s[24:27], s81 offen offset:3168 lds
    buffer_load_dword v92, v105, s[36:39], 0 offen
    s_add_u32 s41, s40, 31
    s_lshr_b32 s41, s41, 5
    s_add_u32 s53, s41, 3
    s_mov_b32 s52, 5
    v_and_b32 v108, 1, v102
    v_lshrrev_b32 v103, 1, v102
    v_mul_u32_u24 v77, 1056, v103
    v_lshl_add_u32 v77, v108, 9, v77
    v_xor_b32 v103, v101, v108
    v_lshl_add_u32 v77, v103, 4, v77
    v_bfe_u32 v109, v95, 2, 2
    v_and_b32 v110, 3, v95
    v_and_b32 v108, 1, v109
    v_lshrrev_b32 v103, 1, v109
    v_lshl_add_u32 v103, v101, 1, v103
    v_mul_u32_u24 v103, 1088, v103
    v_lshl_add_u32 v103, v108, 9, v103
    v_lshl_add_u32 v103, v110, 3, v103
    v_add_u32 v103, 67584, v103
    v_lshlrev_b32 v108, 5, v108
    v_add_u32 v78, v103, v108
    v_sub_u32 v80, v103, v108
    v_add_u32 v79, 34816, v78
    v_add_u32 v81, 34816, v80
    v_lshlrev_b32 v96, 2, v101
    v_and_b32 v108, 7, v102
    v_lshlrev_b32 v103, 9, v108
    v_lshrrev_b32 v108, 3, v102
    v_lshl_add_u32 v103, v108, 6, v103
    v_and_b32 v108, 1, v101
    v_lshl_add_u32 v103, v108, 5, v103
    v_lshrrev_b32 v108, 1, v101
    v_lshl_add_u32 v94, v108, 4, v103
    s_add_u32 s42, s54, 0
    s_add_u32 s62, s54, 4096
    s_add_u32 s63, s54, 8192
    s_add_u32 s88, s54, 12288
    s_mov_b32 s32, s14
    s_and_b32 s33, s15, 65535
    s_mov_b32 s34, 16777216
    s_mov_b32 s35, 131072
    v_mov_b32 v97, 0xff800000
    s_mov_b32 s51, 0x4b800000
    v_mov_b32 v128, 0
    v_mov_b32 v129, 0
    v_mov_b32 v130, 0
    v_mov_b32 v131, 0
    v_mov_b32 v132, 0
    v_mov_b32 v133, 0
    v_mov_b32 v134, 0
    v_mov_b32 v135, 0
    v_mov_b32 v136, 0
    v_mov_b32 v137, 0
    v_mov_b32 v138, 0
    v_mov_b32 v139, 0
    v_mov_b32 v140, 0
    v_mov_b32 v141, 0
    v_mov_b32 v142, 0
    v_mov_b32 v143, 0
    v_mov_b32 v144, 0
    v_mov_b32 v145, 0
    v_mov_b32 v146, 0
    v_mov_b32 v147, 0
    v_mov_b32 v148, 0
    v_mov_b32 v149, 0
    v_mov_b32 v150, 0
    v_mov_b32 v151, 0
    v_mov_b32 v152, 0
    v_mov_b32 v153, 0
    v_mov_b32 v154, 0
    v_mov_b32 v155, 0
    v_mov_b32 v156, 0
    v_mov_b32 v157, 0
    v_mov_b32 v158, 0
    v_mov_b32 v159, 0
    v_mov_b32 v160, 0
    v_mov_b32 v161, 0
    v_mov_b32 v162, 0
    v_mov_b32 v163, 0
    v_mov_b32 v164, 0
    v_mov_b32 v165, 0
    v_mov_b32 v166, 0
    v_mov_b32 v167, 0
    v_mov_b32 v168, 0
    v_mov_b32 v169, 0
    v_mov_b32 v170, 0
    v_mov_b32 v171, 0
    v_mov_b32 v172, 0
    v_mov_b32 v173, 0
    v_mov_b32 v174, 0
    v_mov_b32 v175, 0
    v_mov_b32 v176, 0
    v_mov_b32 v177, 0
    v_mov_b32 v178, 0
    v_mov_b32 v179, 0
    v_mov_b32 v180, 0
    v_mov_b32 v181, 0
    v_mov_b32 v182, 0
    v_mov_b32 v183, 0
    v_mov_b32 v184, 0
    buffer_load_dwordx4 v[32:35], v93, s[20:23], s54 offen offset:256
    buffer_load_dwordx4 v[40:43], v93, s[20:23], s54 offen offset:320
    s_waitcnt vmcnt(18)
    v_lshlrev_b32 v112, 16, v0
    v_and_b32 v113, 0xffff0000, v0
    v_lshlrev_b32 v114, 16, v1
    v_and_b32 v115, 0xffff0000, v1
    v_lshlrev_b32 v116, 16, v2
    v_and_b32 v117, 0xffff0000, v2
    v_lshlrev_b32 v118, 16, v3
    v_and_b32 v119, 0xffff0000, v3
    v_pk_mul_f32 v[112:113], v[112:113], s[48:49]
    v_pk_mul_f32 v[114:115], v[114:115], s[48:49]
    v_pk_mul_f32 v[116:117], v[116:117], s[48:49]
    v_pk_mul_f32 v[118:119], v[118:119], s[48:49]
    v_cvt_pk_bf16_f32 v112, v112, v113
    v_cvt_pk_bf16_f32 v114, v114, v115
    v_cvt_pk_bf16_f32 v116, v116, v117
    v_cvt_pk_bf16_f32 v118, v118, v119
    v_accvgpr_write_b32 a0, v112
    v_accvgpr_write_b32 a1, v114
    v_accvgpr_write_b32 a2, v116
    v_accvgpr_write_b32 a3, v118
    v_mov_b32 v185, 0
    v_mov_b32 v186, 0
    v_mov_b32 v187, 0
    v_mov_b32 v188, 0
    v_mov_b32 v189, 0
    v_mov_b32 v190, 0
    v_mov_b32 v191, 0
    v_mov_b32 v192, 0
    v_mov_b32 v193, 0
    v_mov_b32 v194, 0
    v_mov_b32 v195, 0
    v_mov_b32 v196, 0
    v_mov_b32 v197, 0
    v_mov_b32 v198, 0
    v_mov_b32 v199, 0
    v_mov_b32 v200, 0
    v_mov_b32 v201, 0
    v_mov_b32 v202, 0
    v_mov_b32 v203, 0
    v_mov_b32 v204, 0
    v_mov_b32 v205, 0
    v_mov_b32 v206, 0
    v_mov_b32 v207, 0
    v_mov_b32 v208, 0
    v_mov_b32 v209, 0
    v_mov_b32 v210, 0
    v_mov_b32 v211, 0
    v_mov_b32 v212, 0
    v_mov_b32 v213, 0
    v_mov_b32 v214, 0
    v_mov_b32 v215, 0
    v_mov_b32 v216, 0
    v_mov_b32 v217, 0
    v_mov_b32 v218, 0
    v_mov_b32 v219, 0
    v_mov_b32 v220, 0
    v_mov_b32 v221, 0
    v_mov_b32 v222, 0
    v_mov_b32 v223, 0
    v_mov_b32 v224, 0
    v_mov_b32 v225, 0
    v_mov_b32 v226, 0
    v_mov_b32 v227, 0
    v_mov_b32 v228, 0
    v_mov_b32 v229, 0
    v_mov_b32 v230, 0
    v_mov_b32 v231, 0
    v_mov_b32 v232, 0
    v_mov_b32 v233, 0
    v_mov_b32 v234, 0
    v_mov_b32 v235, 0
    v_mov_b32 v236, 0
    v_mov_b32 v237, 0
    v_mov_b32 v238, 0
    v_mov_b32 v239, 0
    v_mov_b32 v240, 0
    v_mov_b32 v241, 0
    v_mov_b32 v242, 0
    v_mov_b32 v243, 0
    v_mov_b32 v244, 0
    v_mov_b32 v245, 0
    v_mov_b32 v246, 0
    v_mov_b32 v247, 0
    v_mov_b32 v248, 0
    v_mov_b32 v249, 0
    v_mov_b32 v250, 0
    v_mov_b32 v251, 0
    v_mov_b32 v252, 0
    v_mov_b32 v253, 0
    v_mov_b32 v254, 0
    v_mov_b32 v255, 0
    buffer_load_dwordx4 v[36:39], v93, s[20:23], s55 offen offset:256
    buffer_load_dwordx4 v[44:47], v93, s[20:23], s55 offen offset:320
    s_waitcnt vmcnt(18)
    v_lshlrev_b32 v112, 16, v4
    v_and_b32 v113, 0xffff0000, v4
    v_lshlrev_b32 v114, 16, v5
    v_and_b32 v115, 0xffff0000, v5
    v_lshlrev_b32 v116, 16, v6
    v_and_b32 v117, 0xffff0000, v6
    v_lshlrev_b32 v118, 16, v7
    v_and_b32 v119, 0xffff0000, v7
    v_pk_mul_f32 v[112:113], v[112:113], s[48:49]
    v_pk_mul_f32 v[114:115], v[114:115], s[48:49]
    v_pk_mul_f32 v[116:117], v[116:117], s[48:49]
    v_pk_mul_f32 v[118:119], v[118:119], s[48:49]
    v_cvt_pk_bf16_f32 v112, v112, v113
    v_cvt_pk_bf16_f32 v114, v114, v115
    v_cvt_pk_bf16_f32 v116, v116, v117
    v_cvt_pk_bf16_f32 v118, v118, v119
    v_accvgpr_write_b32 a4, v112
    v_accvgpr_write_b32 a5, v114
    v_accvgpr_write_b32 a6, v116
    v_accvgpr_write_b32 a7, v118
    buffer_load_dwordx4 v[48:51], v93, s[20:23], s54 offen offset:384
    buffer_load_dwordx4 v[56:59], v93, s[20:23], s54 offen offset:448
    s_waitcnt vmcnt(63)
    v_lshlrev_b32 v112, 16, v8
    v_and_b32 v113, 0xffff0000, v8
    v_lshlrev_b32 v114, 16, v9
    v_and_b32 v115, 0xffff0000, v9
    v_lshlrev_b32 v116, 16, v10
    v_and_b32 v117, 0xffff0000, v10
    v_lshlrev_b32 v118, 16, v11
    v_and_b32 v119, 0xffff0000, v11
    v_pk_mul_f32 v[112:113], v[112:113], s[48:49]
    v_pk_mul_f32 v[114:115], v[114:115], s[48:49]
    v_pk_mul_f32 v[116:117], v[116:117], s[48:49]
    v_pk_mul_f32 v[118:119], v[118:119], s[48:49]
    v_cvt_pk_bf16_f32 v112, v112, v113
    v_cvt_pk_bf16_f32 v114, v114, v115
    v_cvt_pk_bf16_f32 v116, v116, v117
    v_cvt_pk_bf16_f32 v118, v118, v119
    v_accvgpr_write_b32 a8, v112
    v_accvgpr_write_b32 a9, v114
    v_accvgpr_write_b32 a10, v116
    v_accvgpr_write_b32 a11, v118
    buffer_load_dwordx4 v[52:55], v93, s[20:23], s55 offen offset:384
    buffer_load_dwordx4 v[60:63], v93, s[20:23], s55 offen offset:448
    s_waitcnt vmcnt(21)
    v_lshlrev_b32 v112, 16, v12
    v_and_b32 v113, 0xffff0000, v12
    v_lshlrev_b32 v114, 16, v13
    v_and_b32 v115, 0xffff0000, v13
    v_lshlrev_b32 v116, 16, v14
    v_and_b32 v117, 0xffff0000, v14
    v_lshlrev_b32 v118, 16, v15
    v_and_b32 v119, 0xffff0000, v15
    v_pk_mul_f32 v[112:113], v[112:113], s[48:49]
    v_pk_mul_f32 v[114:115], v[114:115], s[48:49]
    v_pk_mul_f32 v[116:117], v[116:117], s[48:49]
    v_pk_mul_f32 v[118:119], v[118:119], s[48:49]
    v_cvt_pk_bf16_f32 v112, v112, v113
    v_cvt_pk_bf16_f32 v114, v114, v115
    v_cvt_pk_bf16_f32 v116, v116, v117
    v_cvt_pk_bf16_f32 v118, v118, v119
    v_accvgpr_write_b32 a12, v112
    v_accvgpr_write_b32 a13, v114
    v_accvgpr_write_b32 a14, v116
    v_accvgpr_write_b32 a15, v118
    s_waitcnt vmcnt(20)
    v_lshlrev_b32 v112, 16, v16
    v_and_b32 v113, 0xffff0000, v16
    v_lshlrev_b32 v114, 16, v17
    v_and_b32 v115, 0xffff0000, v17
    v_lshlrev_b32 v116, 16, v18
    v_and_b32 v117, 0xffff0000, v18
    v_lshlrev_b32 v118, 16, v19
    v_and_b32 v119, 0xffff0000, v19
    v_pk_mul_f32 v[112:113], v[112:113], s[48:49]
    v_pk_mul_f32 v[114:115], v[114:115], s[48:49]
    v_pk_mul_f32 v[116:117], v[116:117], s[48:49]
    v_pk_mul_f32 v[118:119], v[118:119], s[48:49]
    v_cvt_pk_bf16_f32 v112, v112, v113
    v_cvt_pk_bf16_f32 v114, v114, v115
    v_cvt_pk_bf16_f32 v116, v116, v117
    v_cvt_pk_bf16_f32 v118, v118, v119
    v_accvgpr_write_b32 a16, v112
    v_accvgpr_write_b32 a17, v114
    v_accvgpr_write_b32 a18, v116
    v_accvgpr_write_b32 a19, v118
    s_waitcnt vmcnt(18)
    v_lshlrev_b32 v112, 16, v20
    v_and_b32 v113, 0xffff0000, v20
    v_lshlrev_b32 v114, 16, v21
    v_and_b32 v115, 0xffff0000, v21
    v_lshlrev_b32 v116, 16, v22
    v_and_b32 v117, 0xffff0000, v22
    v_lshlrev_b32 v118, 16, v23
    v_and_b32 v119, 0xffff0000, v23
    v_pk_mul_f32 v[112:113], v[112:113], s[48:49]
    v_pk_mul_f32 v[114:115], v[114:115], s[48:49]
    v_pk_mul_f32 v[116:117], v[116:117], s[48:49]
    v_pk_mul_f32 v[118:119], v[118:119], s[48:49]
    v_cvt_pk_bf16_f32 v112, v112, v113
    v_cvt_pk_bf16_f32 v114, v114, v115
    v_cvt_pk_bf16_f32 v116, v116, v117
    v_cvt_pk_bf16_f32 v118, v118, v119
    v_accvgpr_write_b32 a20, v112
    v_accvgpr_write_b32 a21, v114
    v_accvgpr_write_b32 a22, v116
    v_accvgpr_write_b32 a23, v118
    s_waitcnt vmcnt(63)
    v_lshlrev_b32 v112, 16, v24
    v_and_b32 v113, 0xffff0000, v24
    v_lshlrev_b32 v114, 16, v25
    v_and_b32 v115, 0xffff0000, v25
    v_lshlrev_b32 v116, 16, v26
    v_and_b32 v117, 0xffff0000, v26
    v_lshlrev_b32 v118, 16, v27
    v_and_b32 v119, 0xffff0000, v27
    v_pk_mul_f32 v[112:113], v[112:113], s[48:49]
    v_pk_mul_f32 v[114:115], v[114:115], s[48:49]
    v_pk_mul_f32 v[116:117], v[116:117], s[48:49]
    v_pk_mul_f32 v[118:119], v[118:119], s[48:49]
    v_cvt_pk_bf16_f32 v112, v112, v113
    v_cvt_pk_bf16_f32 v114, v114, v115
    v_cvt_pk_bf16_f32 v116, v116, v117
    v_cvt_pk_bf16_f32 v118, v118, v119
    v_accvgpr_write_b32 a24, v112
    v_accvgpr_write_b32 a25, v114
    v_accvgpr_write_b32 a26, v116
    v_accvgpr_write_b32 a27, v118
    s_waitcnt vmcnt(17)
    v_lshlrev_b32 v112, 16, v28
    v_and_b32 v113, 0xffff0000, v28
    v_lshlrev_b32 v114, 16, v29
    v_and_b32 v115, 0xffff0000, v29
    v_lshlrev_b32 v116, 16, v30
    v_and_b32 v117, 0xffff0000, v30
    v_lshlrev_b32 v118, 16, v31
    v_and_b32 v119, 0xffff0000, v31
    v_pk_mul_f32 v[112:113], v[112:113], s[48:49]
    v_pk_mul_f32 v[114:115], v[114:115], s[48:49]
    v_pk_mul_f32 v[116:117], v[116:117], s[48:49]
    v_pk_mul_f32 v[118:119], v[118:119], s[48:49]
    v_cvt_pk_bf16_f32 v112, v112, v113
    v_cvt_pk_bf16_f32 v114, v114, v115
    v_cvt_pk_bf16_f32 v116, v116, v117
    v_cvt_pk_bf16_f32 v118, v118, v119
    v_accvgpr_write_b32 a28, v112
    v_accvgpr_write_b32 a29, v114
    v_accvgpr_write_b32 a30, v116
    v_accvgpr_write_b32 a31, v118
    s_waitcnt vmcnt(9)
    s_barrier
    ds_read_b128 a[64:67], v77 offset:0
    ds_read_b128 a[128:131], v77 offset:16896
    ds_read_b128 a[96:99], v77 offset:8448
    ds_read_b128 a[160:163], v77 offset:25344
    ds_read_b128 a[68:71], v77 offset:64
    ds_read_b128 a[132:135], v77 offset:16960
    ds_read_b128 a[100:103], v77 offset:8512
    ds_read_b128 a[164:167], v77 offset:25408
    s_waitcnt lgkmcnt(8)
    ds_read_b128 a[72:75], v77 offset:128
    ds_read_b128 a[136:139], v77 offset:17024
    ds_read_b128 a[104:107], v77 offset:8576
    ds_read_b128 a[168:171], v77 offset:25472
    ds_read_b128 a[76:79], v77 offset:192
    ds_read_b128 a[140:143], v77 offset:17088
    ds_read_b128 a[108:111], v77 offset:8640
    ds_read_b128 a[172:175], v77 offset:25536
    s_waitcnt lgkmcnt(8)
    ds_read_b128 a[80:83], v77 offset:256
    ds_read_b128 a[144:147], v77 offset:17152
    ds_read_b128 a[112:115], v77 offset:8704
    ds_read_b128 a[176:179], v77 offset:25600
    ds_read_b128 a[84:87], v77 offset:320
    ds_read_b128 a[148:151], v77 offset:17216
    ds_read_b128 a[116:119], v77 offset:8768
    ds_read_b128 a[180:183], v77 offset:25664
    s_waitcnt lgkmcnt(8)
    ds_read_b128 a[88:91], v77 offset:384
    ds_read_b128 a[152:155], v77 offset:17280
    ds_read_b128 a[120:123], v77 offset:8832
    ds_read_b128 a[184:187], v77 offset:25728
    ds_read_b128 a[92:95], v77 offset:448
    ds_read_b128 a[156:159], v77 offset:17344
    ds_read_b128 a[124:127], v77 offset:8896
    ds_read_b128 a[188:191], v77 offset:25792
    s_waitcnt lgkmcnt(8)
    s_waitcnt lgkmcnt(15)
    v_mfma_f32_16x16x32_bf16 v[0:3], a[64:67], a[0:3], 0
    v_mfma_f32_16x16x32_bf16 v[4:7], a[64:67], a[4:7], 0
    v_mfma_f32_16x16x32_bf16 v[8:11], a[96:99], a[0:3], 0
    v_mfma_f32_16x16x32_bf16 v[12:15], a[96:99], a[4:7], 0
    v_mfma_f32_16x16x32_bf16 v[16:19], a[128:131], a[0:3], 0
    v_mfma_f32_16x16x32_bf16 v[20:23], a[128:131], a[4:7], 0
    v_mfma_f32_16x16x32_bf16 v[24:27], a[160:163], a[0:3], 0
    v_mfma_f32_16x16x32_bf16 v[28:31], a[160:163], a[4:7], 0
    s_waitcnt lgkmcnt(15)
    v_mfma_f32_16x16x32_bf16 v[0:3], a[68:71], a[8:11], v[0:3]
    v_mfma_f32_16x16x32_bf16 v[4:7], a[68:71], a[12:15], v[4:7]
    v_mfma_f32_16x16x32_bf16 v[8:11], a[100:103], a[8:11], v[8:11]
    v_mfma_f32_16x16x32_bf16 v[12:15], a[100:103], a[12:15], v[12:15]
    v_mfma_f32_16x16x32_bf16 v[16:19], a[132:135], a[8:11], v[16:19]
    v_mfma_f32_16x16x32_bf16 v[20:23], a[132:135], a[12:15], v[20:23]
    v_mfma_f32_16x16x32_bf16 v[24:27], a[164:167], a[8:11], v[24:27]
    v_mfma_f32_16x16x32_bf16 v[28:31], a[164:167], a[12:15], v[28:31]
    s_waitcnt lgkmcnt(15)
    v_mfma_f32_16x16x32_bf16 v[0:3], a[72:75], a[16:19], v[0:3]
    v_mfma_f32_16x16x32_bf16 v[4:7], a[72:75], a[20:23], v[4:7]
    v_mfma_f32_16x16x32_bf16 v[8:11], a[104:107], a[16:19], v[8:11]
    v_mfma_f32_16x16x32_bf16 v[12:15], a[104:107], a[20:23], v[12:15]
    v_mfma_f32_16x16x32_bf16 v[16:19], a[136:139], a[16:19], v[16:19]
    v_mfma_f32_16x16x32_bf16 v[20:23], a[136:139], a[20:23], v[20:23]
    v_mfma_f32_16x16x32_bf16 v[24:27], a[168:171], a[16:19], v[24:27]
    v_mfma_f32_16x16x32_bf16 v[28:31], a[168:171], a[20:23], v[28:31]
    s_waitcnt lgkmcnt(15)
    v_mfma_f32_16x16x32_bf16 v[0:3], a[76:79], a[24:27], v[0:3]
    v_mfma_f32_16x16x32_bf16 v[4:7], a[76:79], a[28:31], v[4:7]
    v_mfma_f32_16x16x32_bf16 v[8:11], a[108:111], a[24:27], v[8:11]
    v_mfma_f32_16x16x32_bf16 v[12:15], a[108:111], a[28:31], v[12:15]
    v_mfma_f32_16x16x32_bf16 v[16:19], a[140:143], a[24:27], v[16:19]
    v_mfma_f32_16x16x32_bf16 v[20:23], a[140:143], a[28:31], v[20:23]
    v_mfma_f32_16x16x32_bf16 v[24:27], a[172:175], a[24:27], v[24:27]
    v_mfma_f32_16x16x32_bf16 v[28:31], a[172:175], a[28:31], v[28:31]
    v_cmp_gt_u32 vcc, s56, v104
    v_mov_b32 v103, 0x40000000
    s_waitcnt vmcnt(8)
    v_lshlrev_b32 v92, 16, v92
    v_add_u32 v92, s57, v92
    v_cndmask_b32 v92, v103, v92, vcc
    s_lshr_b32 s59, s45, 2
    s_lshl_b32 s59, s59, 12
    s_and_b32 s60, s45, 3
    s_lshl_b32 s60, s60, 7
    s_add_u32 s59, s59, s60
    v_add_u32 v99, s59, v92
    s_mov_b32 s86, 0
    s_mov_b32 s87, 0x80000000
    s_add_u32 m0, s46, 33792
    s_nop 0
    buffer_load_dwordx4 v84, s[24:27], s82 offen lds
    buffer_load_dwordx4 v85, s[24:27], s82 offen offset:1056 lds
    buffer_load_dwordx4 v86, s[24:27], s82 offen offset:2112 lds
    buffer_load_dwordx4 v87, s[24:27], s82 offen offset:3168 lds
    s_mov_b32 s84, 496
    s_mov_b32 s85, 0
    s_or_b64 exec, s[84:85], s[86:87]
    buffer_load_dword v124, v99, s[24:27], 0 offen
    buffer_load_dword v126, v99, s[28:31], 0 offen
    s_mov_b64 exec, -1
    s_lshl_b64 s[84:85], s[84:85], 4
    s_waitcnt vmcnt(13)
    v_lshlrev_b32 v112, 16, v32
    v_and_b32 v113, 0xffff0000, v32
    v_lshlrev_b32 v114, 16, v33
    v_and_b32 v115, 0xffff0000, v33
    v_lshlrev_b32 v116, 16, v34
    v_and_b32 v117, 0xffff0000, v34
    v_lshlrev_b32 v118, 16, v35
    v_and_b32 v119, 0xffff0000, v35
    v_pk_mul_f32 v[112:113], v[112:113], s[48:49]
    v_pk_mul_f32 v[114:115], v[114:115], s[48:49]
    v_pk_mul_f32 v[116:117], v[116:117], s[48:49]
    v_pk_mul_f32 v[118:119], v[118:119], s[48:49]
    v_cvt_pk_bf16_f32 v112, v112, v113
    v_cvt_pk_bf16_f32 v114, v114, v115
    v_cvt_pk_bf16_f32 v116, v116, v117
    v_cvt_pk_bf16_f32 v118, v118, v119
    v_accvgpr_write_b32 a32, v112
    v_accvgpr_write_b32 a33, v114
    v_accvgpr_write_b32 a34, v116
    v_accvgpr_write_b32 a35, v118
    s_add_u32 m0, s47, 0
    s_nop 0
    buffer_load_dwordx4 v88, s[28:31], s61 offen lds
    buffer_load_dwordx4 v89, s[28:31], s61 offen offset:1088 lds
    buffer_load_dwordx4 v90, s[28:31], s61 offen offset:2176 lds
    buffer_load_dwordx4 v91, s[28:31], s61 offen offset:3264 lds
    s_waitcnt vmcnt(15)
    v_lshlrev_b32 v112, 16, v36
    v_and_b32 v113, 0xffff0000, v36
    v_lshlrev_b32 v114, 16, v37
    v_and_b32 v115, 0xffff0000, v37
    v_lshlrev_b32 v116, 16, v38
    v_and_b32 v117, 0xffff0000, v38
    v_lshlrev_b32 v118, 16, v39
    v_and_b32 v119, 0xffff0000, v39
    v_pk_mul_f32 v[112:113], v[112:113], s[48:49]
    v_pk_mul_f32 v[114:115], v[114:115], s[48:49]
    v_pk_mul_f32 v[116:117], v[116:117], s[48:49]
    v_pk_mul_f32 v[118:119], v[118:119], s[48:49]
    v_cvt_pk_bf16_f32 v112, v112, v113
    v_cvt_pk_bf16_f32 v114, v114, v115
    v_cvt_pk_bf16_f32 v116, v116, v117
    v_cvt_pk_bf16_f32 v118, v118, v119
    v_accvgpr_write_b32 a36, v112
    v_accvgpr_write_b32 a37, v114
    v_accvgpr_write_b32 a38, v116
    v_accvgpr_write_b32 a39, v118
    s_waitcnt lgkmcnt(15)
    s_nop 0
    v_mfma_f32_16x16x32_bf16 v[0:3], a[80:83], a[32:35], v[0:3]
    v_mfma_f32_16x16x32_bf16 v[4:7], a[80:83], a[36:39], v[4:7]
    v_mfma_f32_16x16x32_bf16 v[8:11], a[112:115], a[32:35], v[8:11]
    v_mfma_f32_16x16x32_bf16 v[12:15], a[112:115], a[36:39], v[12:15]
    v_mfma_f32_16x16x32_bf16 v[16:19], a[144:147], a[32:35], v[16:19]
    v_mfma_f32_16x16x32_bf16 v[20:23], a[144:147], a[36:39], v[20:23]
    v_mfma_f32_16x16x32_bf16 v[24:27], a[176:179], a[32:35], v[24:27]
    v_mfma_f32_16x16x32_bf16 v[28:31], a[176:179], a[36:39], v[28:31]
    s_waitcnt vmcnt(63)
    v_lshlrev_b32 v112, 16, v40
    v_and_b32 v113, 0xffff0000, v40
    v_lshlrev_b32 v114, 16, v41
    v_and_b32 v115, 0xffff0000, v41
    v_lshlrev_b32 v116, 16, v42
    v_and_b32 v117, 0xffff0000, v42
    v_lshlrev_b32 v118, 16, v43
    v_and_b32 v119, 0xffff0000, v43
    v_pk_mul_f32 v[112:113], v[112:113], s[48:49]
    v_pk_mul_f32 v[114:115], v[114:115], s[48:49]
    v_pk_mul_f32 v[116:117], v[116:117], s[48:49]
    v_pk_mul_f32 v[118:119], v[118:119], s[48:49]
    v_cvt_pk_bf16_f32 v112, v112, v113
    v_cvt_pk_bf16_f32 v114, v114, v115
    v_cvt_pk_bf16_f32 v116, v116, v117
    v_cvt_pk_bf16_f32 v118, v118, v119
    v_accvgpr_write_b32 a40, v112
    v_accvgpr_write_b32 a41, v114
    v_accvgpr_write_b32 a42, v116
    v_accvgpr_write_b32 a43, v118
    s_waitcnt vmcnt(14)
    v_lshlrev_b32 v112, 16, v44
    v_and_b32 v113, 0xffff0000, v44
    v_lshlrev_b32 v114, 16, v45
    v_and_b32 v115, 0xffff0000, v45
    v_lshlrev_b32 v116, 16, v46
    v_and_b32 v117, 0xffff0000, v46
    v_lshlrev_b32 v118, 16, v47
    v_and_b32 v119, 0xffff0000, v47
    v_pk_mul_f32 v[112:113], v[112:113], s[48:49]
    v_pk_mul_f32 v[114:115], v[114:115], s[48:49]
    v_pk_mul_f32 v[116:117], v[116:117], s[48:49]
    v_pk_mul_f32 v[118:119], v[118:119], s[48:49]
    v_cvt_pk_bf16_f32 v112, v112, v113
    v_cvt_pk_bf16_f32 v114, v114, v115
    v_cvt_pk_bf16_f32 v116, v116, v117
    v_cvt_pk_bf16_f32 v118, v118, v119
    v_accvgpr_write_b32 a44, v112
    v_accvgpr_write_b32 a45, v114
    v_accvgpr_write_b32 a46, v116
    v_accvgpr_write_b32 a47, v118
    s_waitcnt lgkmcnt(15)
    s_nop 0
    v_mfma_f32_16x16x32_bf16 v[0:3], a[84:87], a[40:43], v[0:3]
    v_mfma_f32_16x16x32_bf16 v[4:7], a[84:87], a[44:47], v[4:7]
    v_mfma_f32_16x16x32_bf16 v[8:11], a[116:119], a[40:43], v[8:11]
    v_mfma_f32_16x16x32_bf16 v[12:15], a[116:119], a[44:47], v[12:15]
    v_mfma_f32_16x16x32_bf16 v[16:19], a[148:151], a[40:43], v[16:19]
    v_mfma_f32_16x16x32_bf16 v[20:23], a[148:151], a[44:47], v[20:23]
    v_mfma_f32_16x16x32_bf16 v[24:27], a[180:183], a[40:43], v[24:27]
    v_mfma_f32_16x16x32_bf16 v[28:31], a[180:183], a[44:47], v[28:31]
    s_add_u32 m0, s46, 50688
    s_nop 0
    buffer_load_dwordx4 v84, s[24:27], s83 offen lds
    buffer_load_dwordx4 v85, s[24:27], s83 offen offset:1056 lds
    buffer_load_dwordx4 v86, s[24:27], s83 offen offset:2112 lds
    buffer_load_dwordx4 v87, s[24:27], s83 offen offset:3168 lds
    s_waitcnt vmcnt(17)
    v_lshlrev_b32 v112, 16, v48
    v_and_b32 v113, 0xffff0000, v48
    v_lshlrev_b32 v114, 16, v49
    v_and_b32 v115, 0xffff0000, v49
    v_lshlrev_b32 v116, 16, v50
    v_and_b32 v117, 0xffff0000, v50
    v_lshlrev_b32 v118, 16, v51
    v_and_b32 v119, 0xffff0000, v51
    v_pk_mul_f32 v[112:113], v[112:113], s[48:49]
    v_pk_mul_f32 v[114:115], v[114:115], s[48:49]
    v_pk_mul_f32 v[116:117], v[116:117], s[48:49]
    v_pk_mul_f32 v[118:119], v[118:119], s[48:49]
    v_cvt_pk_bf16_f32 v112, v112, v113
    v_cvt_pk_bf16_f32 v114, v114, v115
    v_cvt_pk_bf16_f32 v116, v116, v117
    v_cvt_pk_bf16_f32 v118, v118, v119
    v_accvgpr_write_b32 a48, v112
    v_accvgpr_write_b32 a49, v114
    v_accvgpr_write_b32 a50, v116
    v_accvgpr_write_b32 a51, v118
    s_waitcnt vmcnt(15)
    v_lshlrev_b32 v112, 16, v52
    v_and_b32 v113, 0xffff0000, v52
    v_lshlrev_b32 v114, 16, v53
    v_and_b32 v115, 0xffff0000, v53
    v_lshlrev_b32 v116, 16, v54
    v_and_b32 v117, 0xffff0000, v54
    v_lshlrev_b32 v118, 16, v55
    v_and_b32 v119, 0xffff0000, v55
    v_pk_mul_f32 v[112:113], v[112:113], s[48:49]
    v_pk_mul_f32 v[114:115], v[114:115], s[48:49]
    v_pk_mul_f32 v[116:117], v[116:117], s[48:49]
    v_pk_mul_f32 v[118:119], v[118:119], s[48:49]
    v_cvt_pk_bf16_f32 v112, v112, v113
    v_cvt_pk_bf16_f32 v114, v114, v115
    v_cvt_pk_bf16_f32 v116, v116, v117
    v_cvt_pk_bf16_f32 v118, v118, v119
    v_accvgpr_write_b32 a52, v112
    v_accvgpr_write_b32 a53, v114
    v_accvgpr_write_b32 a54, v116
    v_accvgpr_write_b32 a55, v118
    s_waitcnt lgkmcnt(4)
    s_nop 0
    v_mfma_f32_16x16x32_bf16 v[0:3], a[88:91], a[48:51], v[0:3]
    v_mfma_f32_16x16x32_bf16 v[4:7], a[88:91], a[52:55], v[4:7]
    v_mfma_f32_16x16x32_bf16 v[8:11], a[120:123], a[48:51], v[8:11]
    v_mfma_f32_16x16x32_bf16 v[12:15], a[120:123], a[52:55], v[12:15]
    v_mfma_f32_16x16x32_bf16 v[16:19], a[152:155], a[48:51], v[16:19]
    v_mfma_f32_16x16x32_bf16 v[20:23], a[152:155], a[52:55], v[20:23]
    v_mfma_f32_16x16x32_bf16 v[24:27], a[184:187], a[48:51], v[24:27]
    v_mfma_f32_16x16x32_bf16 v[28:31], a[184:187], a[52:55], v[28:31]
    s_add_u32 m0, s47, 17408
    s_nop 0
    buffer_load_dwordx4 v88, s[28:31], s81 offen lds
    buffer_load_dwordx4 v89, s[28:31], s81 offen offset:1088 lds
    buffer_load_dwordx4 v90, s[28:31], s81 offen offset:2176 lds
    buffer_load_dwordx4 v91, s[28:31], s81 offen offset:3264 lds
    s_waitcnt vmcnt(63)
    v_lshlrev_b32 v112, 16, v56
    v_and_b32 v113, 0xffff0000, v56
    v_lshlrev_b32 v114, 16, v57
    v_and_b32 v115, 0xffff0000, v57
    v_lshlrev_b32 v116, 16, v58
    v_and_b32 v117, 0xffff0000, v58
    v_lshlrev_b32 v118, 16, v59
    v_and_b32 v119, 0xffff0000, v59
    v_pk_mul_f32 v[112:113], v[112:113], s[48:49]
    v_pk_mul_f32 v[114:115], v[114:115], s[48:49]
    v_pk_mul_f32 v[116:117], v[116:117], s[48:49]
    v_pk_mul_f32 v[118:119], v[118:119], s[48:49]
    v_cvt_pk_bf16_f32 v112, v112, v113
    v_cvt_pk_bf16_f32 v114, v114, v115
    v_cvt_pk_bf16_f32 v116, v116, v117
    v_cvt_pk_bf16_f32 v118, v118, v119
    v_accvgpr_write_b32 a56, v112
    v_accvgpr_write_b32 a57, v114
    v_accvgpr_write_b32 a58, v116
    v_accvgpr_write_b32 a59, v118
    s_waitcnt vmcnt(18)
    v_lshlrev_b32 v112, 16, v60
    v_and_b32 v113, 0xffff0000, v60
    v_lshlrev_b32 v114, 16, v61
    v_and_b32 v115, 0xffff0000, v61
    v_lshlrev_b32 v116, 16, v62
    v_and_b32 v117, 0xffff0000, v62
    v_lshlrev_b32 v118, 16, v63
    v_and_b32 v119, 0xffff0000, v63
    v_pk_mul_f32 v[112:113], v[112:113], s[48:49]
    v_pk_mul_f32 v[114:115], v[114:115], s[48:49]
    v_pk_mul_f32 v[116:117], v[116:117], s[48:49]
    v_pk_mul_f32 v[118:119], v[118:119], s[48:49]
    v_cvt_pk_bf16_f32 v112, v112, v113
    v_cvt_pk_bf16_f32 v114, v114, v115
    v_cvt_pk_bf16_f32 v116, v116, v117
    v_cvt_pk_bf16_f32 v118, v118, v119
    v_accvgpr_write_b32 a60, v112
    v_accvgpr_write_b32 a61, v114
    v_accvgpr_write_b32 a62, v116
    v_accvgpr_write_b32 a63, v118
    s_waitcnt lgkmcnt(0)
    s_nop 0
    v_mfma_f32_16x16x32_bf16 v[0:3], a[92:95], a[56:59], v[0:3]
    v_mfma_f32_16x16x32_bf16 v[4:7], a[92:95], a[60:63], v[4:7]
    v_mfma_f32_16x16x32_bf16 v[8:11], a[124:127], a[56:59], v[8:11]
    v_mfma_f32_16x16x32_bf16 v[12:15], a[124:127], a[60:63], v[12:15]
    v_mfma_f32_16x16x32_bf16 v[16:19], a[156:159], a[56:59], v[16:19]
    v_mfma_f32_16x16x32_bf16 v[20:23], a[156:159], a[60:63], v[20:23]
    v_mfma_f32_16x16x32_bf16 v[24:27], a[188:191], a[56:59], v[24:27]
    v_mfma_f32_16x16x32_bf16 v[28:31], a[188:191], a[60:63], v[28:31]
    s_waitcnt vmcnt(8)
    s_barrier
    s_add_u32 m0, s46, 0
    s_nop 0
    buffer_load_dwordx4 v84, s[24:27], s80 offen lds
    buffer_load_dwordx4 v85, s[24:27], s80 offen offset:1056 lds
    buffer_load_dwordx4 v86, s[24:27], s80 offen offset:2112 lds
    buffer_load_dwordx4 v87, s[24:27], s80 offen offset:3168 lds
    s_add_u32 m0, s47, 34816
    s_nop 0
    buffer_load_dwordx4 v88, s[28:31], s82 offen lds
    buffer_load_dwordx4 v89, s[28:31], s82 offen offset:1088 lds
    buffer_load_dwordx4 v90, s[28:31], s82 offen offset:2176 lds
    buffer_load_dwordx4 v91, s[28:31], s82 offen offset:3264 lds
    s_cmp_ge_u32 s40, 32
    s_cbranch_scc1 L_nomask0
    v_sub_u32 v98, s40, v96
    v_cmp_lt_i32_e64 s[64:65], 0, v98
    v_cmp_lt_i32_e64 s[66:67], 1, v98
    v_cmp_lt_i32_e64 s[68:69], 2, v98
    v_cmp_lt_i32_e64 s[70:71], 3, v98
    v_cmp_lt_i32_e64 s[72:73], 16, v98
    v_cmp_lt_i32_e64 s[74:75], 17, v98
    v_cmp_lt_i32_e64 s[76:77], 18, v98
    v_cmp_lt_i32_e64 s[78:79], 19, v98
    s_nop 1
    v_cndmask_b32_e64 v0, v97, v0, s[64:65]
    v_cndmask_b32_e64 v1, v97, v1, s[66:67]
    v_cndmask_b32_e64 v2, v97, v2, s[68:69]
    v_cndmask_b32_e64 v3, v97, v3, s[70:71]
    v_cndmask_b32_e64 v4, v97, v4, s[64:65]
    v_cndmask_b32_e64 v5, v97, v5, s[66:67]
    v_cndmask_b32_e64 v6, v97, v6, s[68:69]
    v_cndmask_b32_e64 v7, v97, v7, s[70:71]
    v_cndmask_b32_e64 v8, v97, v8, s[72:73]
    v_cndmask_b32_e64 v9, v97, v9, s[74:75]
    v_cndmask_b32_e64 v10, v97, v10, s[76:77]
    v_cndmask_b32_e64 v11, v97, v11, s[78:79]
    v_cndmask_b32_e64 v12, v97, v12, s[72:73]
    v_cndmask_b32_e64 v13, v97, v13, s[74:75]
    v_cndmask_b32_e64 v14, v97, v14, s[76:77]
    v_cndmask_b32_e64 v15, v97, v15, s[78:79]
L_nomask0:
    ds_read_b128 a[64:67], v77 offset:33792
    v_max3_f32 v100, v0, v1, v2
    v_max3_f32 v102, v3, v8, v9
    v_max3_f32 v101, v4, v5, v6
    ds_read_b128 a[68:71], v77 offset:33856
    v_max3_f32 v103, v7, v12, v13
    v_max3_f32 v100, v100, v10, v11
    v_max3_f32 v101, v101, v14, v15
    ds_read_b128 a[72:75], v77 offset:33920
    v_max_f32 v100, v100, v102
    v_max_f32 v101, v101, v103
    v_mov_b32 v102, v100
    ds_read_b128 a[76:79], v77 offset:33984
    v_mov_b32 v103, v101
    s_nop 1
    v_permlane32_swap_b32 v100, v102
    ds_read_b128 a[80:83], v77 offset:34048
    v_permlane32_swap_b32 v101, v103
    s_nop 1
    v_max_f32 v100, v100, v102
    ds_read_b128 a[84:87], v77 offset:34112
    v_max_f32 v101, v101, v103
    v_mov_b32 v102, v100
    v_mov_b32 v103, v101
    ds_read_b128 a[88:91], v77 offset:34176
    s_nop 1
    v_permlane16_swap_b32 v100, v102
    v_permlane16_swap_b32 v101, v103
    ds_read_b128 a[92:95], v77 offset:34240
    s_nop 1
    v_max_f32 v100, v100, v102
    v_max_f32 v101, v101, v103
    ds_read_b128 a[96:99], v77 offset:42240
    v_add_f32 v100, 0x40400000, v100
    v_add_f32 v101, 0x40400000, v101
    v_sub_f32 v32, 0, v100
    ds_read_b128 a[100:103], v77 offset:42304
    v_sub_f32 v33, 0, v100
    v_sub_f32 v34, 0, v100
    v_sub_f32 v35, 0, v100
    ds_read_b128 a[104:107], v77 offset:42368
    v_sub_f32 v36, 0, v101
    v_sub_f32 v37, 0, v101
    v_sub_f32 v38, 0, v101
    ds_read_b64_tr_b16 a[128:129], v78 offset:0
    v_sub_f32 v39, 0, v101
    v_sub_f32 v0, v0, v100
    v_sub_f32 v1, v1, v100
    ds_read_b64_tr_b16 a[130:131], v78 offset:8704
    v_sub_f32 v2, v2, v100
    v_sub_f32 v3, v3, v100
    v_sub_f32 v4, v4, v101
    ds_read_b64_tr_b16 a[132:133], v80 offset:32
    v_sub_f32 v5, v5, v101
    v_sub_f32 v6, v6, v101
    v_sub_f32 v7, v7, v101
    ds_read_b64_tr_b16 a[134:135], v80 offset:8736
    v_sub_f32 v8, v8, v100
    v_sub_f32 v9, v9, v100
    v_sub_f32 v10, v10, v100
    ds_read_b64_tr_b16 a[136:137], v78 offset:64
    v_sub_f32 v11, v11, v100
    v_sub_f32 v12, v12, v101
    v_sub_f32 v13, v13, v101
    ds_read_b64_tr_b16 a[138:139], v78 offset:8768
    v_sub_f32 v14, v14, v101
    v_sub_f32 v15, v15, v101
    v_sub_f32 v16, v16, v100
    ds_read_b64_tr_b16 a[140:141], v80 offset:96
    v_sub_f32 v17, v17, v100
    v_sub_f32 v18, v18, v100
    v_sub_f32 v19, v19, v100
    ds_read_b64_tr_b16 a[142:143], v80 offset:8800
    v_sub_f32 v20, v20, v101
    v_sub_f32 v21, v21, v101
    v_sub_f32 v22, v22, v101
    ds_read_b64_tr_b16 a[144:145], v78 offset:128
    v_sub_f32 v23, v23, v101
    v_sub_f32 v24, v24, v100
    v_sub_f32 v25, v25, v100
    ds_read_b64_tr_b16 a[146:147], v78 offset:8832
    v_sub_f32 v26, v26, v100
    v_sub_f32 v27, v27, v100
    v_sub_f32 v28, v28, v101
    ds_read_b64_tr_b16 a[148:149], v80 offset:160
    v_sub_f32 v29, v29, v101
    v_sub_f32 v30, v30, v101
    v_sub_f32 v31, v31, v101
    ds_read_b64_tr_b16 a[150:151], v80 offset:8864
    v_exp_f32 v56, v0
    v_exp_f32 v57, v1
    v_exp_f32 v58, v2
    ds_read_b64_tr_b16 a[152:153], v78 offset:192
    v_exp_f32 v59, v3
    v_exp_f32 v60, v4
    v_exp_f32 v61, v5
    ds_read_b64_tr_b16 a[154:155], v78 offset:8896
    v_exp_f32 v62, v6
    v_exp_f32 v63, v7
    v_exp_f32 v64, v8
    ds_read_b64_tr_b16 a[156:157], v80 offset:224
    v_exp_f32 v65, v9
    v_exp_f32 v66, v10
    v_exp_f32 v67, v11
    ds_read_b64_tr_b16 a[158:159], v80 offset:8928
    v_exp_f32 v68, v12
    v_exp_f32 v69, v13
    v_exp_f32 v70, v14
    ds_read_b64_tr_b16 a[160:161], v78 offset:256
    v_exp_f32 v71, v15
    v_add_f32 v74, v56, v57
    v_add_f32 v74, v74, v58
    ds_read_b64_tr_b16 a[162:163], v78 offset:8960
    v_add_f32 v74, v74, v59
    v_add_f32 v75, v60, v61
    v_add_f32 v75, v75, v62
    ds_read_b64_tr_b16 a[164:165], v80 offset:288
    v_add_f32 v75, v75, v63
    v_add_f32 v74, v74, v64
    v_add_f32 v74, v74, v65
    ds_read_b64_tr_b16 a[166:167], v80 offset:8992
    v_add_f32 v74, v74, v66
    v_add_f32 v74, v74, v67
    v_add_f32 v75, v75, v68
    ds_read_b64_tr_b16 a[168:169], v78 offset:320
    v_add_f32 v75, v75, v69
    v_add_f32 v75, v75, v70
    v_add_f32 v75, v75, v71
    ds_read_b64_tr_b16 a[170:171], v78 offset:9024
    v_cvt_pk_bf16_f32 v40, v56, v57
    v_cvt_pk_bf16_f32 v41, v58, v59
    v_cvt_pk_bf16_f32 v44, v60, v61
    v_cvt_pk_bf16_f32 v45, v62, v63
    v_cvt_pk_bf16_f32 v42, v64, v65
    v_cvt_pk_bf16_f32 v43, v66, v67
    v_cvt_pk_bf16_f32 v46, v68, v69
    v_cvt_pk_bf16_f32 v47, v70, v71
    v_mov_b32 v72, v74
    v_mov_b32 v73, v75
    s_mov_b32 s84, 7680
    s_mov_b32 s85, 0
    s_cmp_eq_u32 s41, 1
    s_cbranch_scc1 L_tailB0
    s_cmp_eq_u32 s41, 2
    s_cbranch_scc1 L_tailA0
    v_exp_f32 v56, v16
    v_exp_f32 v57, v17
.p2align 6
L_ph0:
    s_waitcnt lgkmcnt(9)
    v_mfma_f32_16x16x32_bf16 v[0:3], a[64:67], a[0:3], v[32:35]
    v_exp_f32 v58, v18
    v_mfma_f32_16x16x32_bf16 v[0:3], a[68:71], a[8:11], v[0:3]
    ds_read_b64_tr_b16 a[172:173], v80 offset:352
    ds_read_b64_tr_b16 a[174:175], v80 offset:9056
    v_mfma_f32_16x16x32_bf16 v[0:3], a[72:75], a[16:19], v[0:3]
    ds_read_b128 a[108:111], v77 offset:42432
    v_add_f32 v74, v56, v57
    v_mfma_f32_16x16x32_bf16 v[0:3], a[76:79], a[24:27], v[0:3]
    v_cvt_pk_bf16_f32 v48, v56, v57
    v_mfma_f32_16x16x32_bf16 v[0:3], a[80:83], a[32:35], v[0:3]
    v_exp_f32 v59, v19
    v_mfma_f32_16x16x32_bf16 v[0:3], a[84:87], a[40:43], v[0:3]
    ds_read_b64_tr_b16 a[176:177], v78 offset:384
    ds_read_b64_tr_b16 a[178:179], v78 offset:9088
    v_mfma_f32_16x16x32_bf16 v[0:3], a[88:91], a[48:51], v[0:3]
    ds_read_b128 a[112:115], v77 offset:42496
    v_add_f32 v74, v74, v58
    v_mfma_f32_16x16x32_bf16 v[0:3], a[92:95], a[56:59], v[0:3]
    v_cvt_pk_bf16_f32 v49, v58, v59
    v_mfma_f32_16x16x32_bf16 v[4:7], a[64:67], a[4:7], v[36:39]
    v_exp_f32 v60, v20
    v_mfma_f32_16x16x32_bf16 v[4:7], a[68:71], a[12:15], v[4:7]
    ds_read_b64_tr_b16 a[180:181], v80 offset:416
    ds_read_b64_tr_b16 a[182:183], v80 offset:9120
    v_mfma_f32_16x16x32_bf16 v[4:7], a[72:75], a[20:23], v[4:7]
    ds_read_b128 a[116:119], v77 offset:42560
    v_add_f32 v74, v74, v59
    v_mfma_f32_16x16x32_bf16 v[4:7], a[76:79], a[28:31], v[4:7]
    s_or_b64 exec, s[84:85], s[86:87]
    buffer_load_dword v124, v99, s[24:27], 0 offen
    buffer_load_dword v126, v99, s[28:31], 0 offen
    s_mov_b64 exec, -1
    s_lshl_b64 s[84:85], s[84:85], 4
    v_mfma_f32_16x16x32_bf16 v[4:7], a[80:83], a[36:39], v[4:7]
    v_exp_f32 v61, v21
    v_mfma_f32_16x16x32_bf16 v[4:7], a[84:87], a[44:47], v[4:7]
    ds_read_b64_tr_b16 a[184:185], v78 offset:448
    ds_read_b64_tr_b16 a[186:187], v78 offset:9152
    v_mfma_f32_16x16x32_bf16 v[4:7], a[88:91], a[52:55], v[4:7]
    ds_read_b128 a[120:123], v77 offset:42624
    v_add_f32 v75, v60, v61
    v_mfma_f32_16x16x32_bf16 v[4:7], a[92:95], a[60:63], v[4:7]
    v_cvt_pk_bf16_f32 v52, v60, v61
    v_readlane_b32 s81, v92, s52
    s_waitcnt lgkmcnt(15)
    v_mfma_f32_16x16x32_bf16 v[128:131], a[128:131], v[40:43], v[128:131]
    v_exp_f32 v62, v22
    v_mfma_f32_16x16x32_bf16 v[132:135], a[128:131], v[44:47], v[132:135]
    ds_read_b64_tr_b16 a[188:189], v80 offset:480
    ds_read_b64_tr_b16 a[190:191], v80 offset:9184
    v_mfma_f32_16x16x32_bf16 v[136:139], a[132:135], v[40:43], v[136:139]
    ds_read_b128 a[124:127], v77 offset:42688
    v_add_f32 v75, v75, v62
    v_mfma_f32_16x16x32_bf16 v[140:143], a[132:135], v[44:47], v[140:143]
    s_add_u32 s52, s52, 1
    s_waitcnt vmcnt(10)
    s_barrier
    v_mfma_f32_16x16x32_bf16 v[144:147], a[136:139], v[40:43], v[144:147]
    v_exp_f32 v63, v23
    v_mfma_f32_16x16x32_bf16 v[148:151], a[136:139], v[44:47], v[148:151]
    ds_read_b64_tr_b16 a[128:129], v78 offset:17408
    ds_read_b64_tr_b16 a[130:131], v78 offset:26112
    v_mfma_f32_16x16x32_bf16 v[152:155], a[140:143], v[40:43], v[152:155]
    ds_read_b128 a[64:67], v77 offset:50688
    s_add_u32 m0, s46, 16896
    v_add_f32 v75, v75, v63
    v_mfma_f32_16x16x32_bf16 v[156:159], a[140:143], v[44:47], v[156:159]
    buffer_load_dwordx4 v84, s[24:27], s81 offen lds
    v_cvt_pk_bf16_f32 v53, v62, v63
    v_mfma_f32_16x16x32_bf16 v[160:163], a[144:147], v[40:43], v[160:163]
    v_exp_f32 v64, v24
    v_mfma_f32_16x16x32_bf16 v[164:167], a[144:147], v[44:47], v[164:167]
    ds_read_b64_tr_b16 a[132:133], v80 offset:17440
    ds_read_b64_tr_b16 a[134:135], v80 offset:26144
    v_mfma_f32_16x16x32_bf16 v[168:171], a[148:151], v[40:43], v[168:171]
    ds_read_b128 a[68:71], v77 offset:50752
    v_add_f32 v74, v74, v64
    v_mfma_f32_16x16x32_bf16 v[172:175], a[148:151], v[44:47], v[172:175]
    buffer_load_dwordx4 v85, s[24:27], s81 offen offset:1056 lds
    v_mfma_f32_16x16x32_bf16 v[176:179], a[152:155], v[40:43], v[176:179]
    v_exp_f32 v65, v25
    v_mfma_f32_16x16x32_bf16 v[180:183], a[152:155], v[44:47], v[180:183]
    ds_read_b64_tr_b16 a[136:137], v78 offset:17472
    ds_read_b64_tr_b16 a[138:139], v78 offset:26176
    v_mfma_f32_16x16x32_bf16 v[184:187], a[156:159], v[40:43], v[184:187]
    ds_read_b128 a[72:75], v77 offset:50816
    v_add_f32 v74, v74, v65
    v_mfma_f32_16x16x32_bf16 v[188:191], a[156:159], v[44:47], v[188:191]
    buffer_load_dwordx4 v86, s[24:27], s81 offen offset:2112 lds
    v_cvt_pk_bf16_f32 v50, v64, v65
    s_waitcnt lgkmcnt(9)
    v_mfma_f32_16x16x32_bf16 v[8:11], a[96:99], a[0:3], v[32:35]
    v_exp_f32 v66, v26
    v_mfma_f32_16x16x32_bf16 v[8:11], a[100:103], a[8:11], v[8:11]
    ds_read_b64_tr_b16 a[140:141], v80 offset:17504
    ds_read_b64_tr_b16 a[142:143], v80 offset:26208
    v_mfma_f32_16x16x32_bf16 v[8:11], a[104:107], a[16:19], v[8:11]
    ds_read_b128 a[76:79], v77 offset:50880
    v_add_f32 v74, v74, v66
    v_mfma_f32_16x16x32_bf16 v[8:11], a[108:111], a[24:27], v[8:11]
    buffer_load_dwordx4 v87, s[24:27], s81 offen offset:3168 lds
    v_mfma_f32_16x16x32_bf16 v[8:11], a[112:115], a[32:35], v[8:11]
    v_exp_f32 v67, v27
    v_mfma_f32_16x16x32_bf16 v[8:11], a[116:119], a[40:43], v[8:11]
    ds_read_b64_tr_b16 a[144:145], v78 offset:17536
    ds_read_b64_tr_b16 a[146:147], v78 offset:26240
    v_mfma_f32_16x16x32_bf16 v[8:11], a[120:123], a[48:51], v[8:11]
    ds_read_b128 a[80:83], v77 offset:50944
    v_add_f32 v74, v74, v67
    v_mfma_f32_16x16x32_bf16 v[8:11], a[124:127], a[56:59], v[8:11]
    v_cvt_pk_bf16_f32 v51, v66, v67
    v_mfma_f32_16x16x32_bf16 v[12:15], a[96:99], a[4:7], v[36:39]
    v_exp_f32 v68, v28
    v_mfma_f32_16x16x32_bf16 v[12:15], a[100:103], a[12:15], v[12:15]
    ds_read_b64_tr_b16 a[148:149], v80 offset:17568
    ds_read_b64_tr_b16 a[150:151], v80 offset:26272
    v_mfma_f32_16x16x32_bf16 v[12:15], a[104:107], a[20:23], v[12:15]
    ds_read_b128 a[84:87], v77 offset:51008
    s_add_u32 m0, s47, 52224
    v_add_f32 v75, v75, v68
    v_mfma_f32_16x16x32_bf16 v[12:15], a[108:111], a[28:31], v[12:15]
    buffer_load_dwordx4 v88, s[28:31], s83 offen lds
    v_mfma_f32_16x16x32_bf16 v[12:15], a[112:115], a[36:39], v[12:15]
    v_exp_f32 v69, v29
    v_mfma_f32_16x16x32_bf16 v[12:15], a[116:119], a[44:47], v[12:15]
    ds_read_b64_tr_b16 a[152:153], v78 offset:17600
    ds_read_b64_tr_b16 a[154:155], v78 offset:26304
    v_mfma_f32_16x16x32_bf16 v[12:15], a[120:123], a[52:55], v[12:15]
    ds_read_b128 a[88:91], v77 offset:51072
    v_add_f32 v75, v75, v69
    v_mfma_f32_16x16x32_bf16 v[12:15], a[124:127], a[60:63], v[12:15]
    v_cvt_pk_bf16_f32 v54, v68, v69
    s_waitcnt lgkmcnt(15)
    v_mfma_f32_16x16x32_bf16 v[192:195], a[160:163], v[40:43], v[192:195]
    v_exp_f32 v70, v30
    v_mfma_f32_16x16x32_bf16 v[196:199], a[160:163], v[44:47], v[196:199]
    ds_read_b64_tr_b16 a[156:157], v80 offset:17632
    ds_read_b64_tr_b16 a[158:159], v80 offset:26336
    v_mfma_f32_16x16x32_bf16 v[200:203], a[164:167], v[40:43], v[200:203]
    ds_read_b128 a[92:95], v77 offset:51136
    v_add_f32 v75, v75, v70
    v_mfma_f32_16x16x32_bf16 v[204:207], a[164:167], v[44:47], v[204:207]
    buffer_load_dwordx4 v89, s[28:31], s83 offen offset:1088 lds
    v_mfma_f32_16x16x32_bf16 v[208:211], a[168:171], v[40:43], v[208:211]
    v_exp_f32 v71, v31
    v_mfma_f32_16x16x32_bf16 v[212:215], a[168:171], v[44:47], v[212:215]
    ds_read_b64_tr_b16 a[160:161], v78 offset:17664
    ds_read_b64_tr_b16 a[162:163], v78 offset:26368
    v_mfma_f32_16x16x32_bf16 v[216:219], a[172:175], v[40:43], v[216:219]
    ds_read_b128 a[96:99], v77 offset:59136
    v_add_f32 v75, v75, v71
    v_mfma_f32_16x16x32_bf16 v[220:223], a[172:175], v[44:47], v[220:223]
    buffer_load_dwordx4 v90, s[28:31], s83 offen offset:2176 lds
    v_cvt_pk_bf16_f32 v55, v70, v71
    v_max_f32 v76, v74, v75
    v_mfma_f32_16x16x32_bf16 v[224:227], a[176:179], v[40:43], v[224:227]
    v_exp_f32 v56, v0
    v_mfma_f32_16x16x32_bf16 v[228:231], a[176:179], v[44:47], v[228:231]
    ds_read_b64_tr_b16 a[164:165], v80 offset:17696
    ds_read_b64_tr_b16 a[166:167], v80 offset:26400
    v_mfma_f32_16x16x32_bf16 v[232:235], a[180:183], v[40:43], v[232:235]
    ds_read_b128 a[100:103], v77 offset:59200
    v_cmp_lt_f32 vcc, s51, v76
    v_mfma_f32_16x16x32_bf16 v[236:239], a[180:183], v[44:47], v[236:239]
    buffer_load_dwordx4 v91, s[28:31], s83 offen offset:3264 lds
    v_mfma_f32_16x16x32_bf16 v[240:243], a[184:187], v[40:43], v[240:243]
    v_exp_f32 v57, v1
    v_mfma_f32_16x16x32_bf16 v[244:247], a[184:187], v[44:47], v[244:247]
    ds_read_b64_tr_b16 a[168:169], v78 offset:17728
    ds_read_b64_tr_b16 a[170:171], v78 offset:26432
    v_mfma_f32_16x16x32_bf16 v[248:251], a[188:191], v[40:43], v[248:251]
    ds_read_b128 a[104:107], v77 offset:59264
    v_mfma_f32_16x16x32_bf16 v[252:255], a[188:191], v[44:47], v[252:255]
    s_cbranch_vccnz L_rare0
L_back0:
    v_add_f32 v72, v72, v74
    v_add_f32 v73, v73, v75
    s_cmp_eq_u32 s52, s53
    s_cbranch_scc1 L_tailA1
L_ph1:
    s_waitcnt lgkmcnt(9)
    v_mfma_f32_16x16x32_bf16 v[16:19], a[64:67], a[0:3], v[32:35]
    v_exp_f32 v58, v2
    v_mfma_f32_16x16x32_bf16 v[16:19], a[68:71], a[8:11], v[16:19]
    ds_read_b64_tr_b16 a[172:173], v80 offset:17760
    ds_read_b64_tr_b16 a[174:175], v80 offset:26464
    v_mfma_f32_16x16x32_bf16 v[16:19], a[72:75], a[16:19], v[16:19]
    ds_read_b128 a[108:111], v77 offset:59328
    v_add_f32 v74, v56, v57
    v_mfma_f32_16x16x32_bf16 v[16:19], a[76:79], a[24:27], v[16:19]
    v_cvt_pk_bf16_f32 v40, v56, v57
    v_mfma_f32_16x16x32_bf16 v[16:19], a[80:83], a[32:35], v[16:19]
    v_exp_f32 v59, v3
    v_mfma_f32_16x16x32_bf16 v[16:19], a[84:87], a[40:43], v[16:19]
    ds_read_b64_tr_b16 a[176:177], v78 offset:17792
    ds_read_b64_tr_b16 a[178:179], v78 offset:26496
    v_mfma_f32_16x16x32_bf16 v[16:19], a[88:91], a[48:51], v[16:19]
    ds_read_b128 a[112:115], v77 offset:59392
    v_add_f32 v74, v74, v58
    v_mfma_f32_16x16x32_bf16 v[16:19], a[92:95], a[56:59], v[16:19]
    v_cvt_pk_bf16_f32 v41, v58, v59
    v_mfma_f32_16x16x32_bf16 v[20:23], a[64:67], a[4:7], v[36:39]
    v_exp_f32 v60, v4
    v_mfma_f32_16x16x32_bf16 v[20:23], a[68:71], a[12:15], v[20:23]
    ds_read_b64_tr_b16 a[180:181], v80 offset:17824
    ds_read_b64_tr_b16 a[182:183], v80 offset:26528
    v_mfma_f32_16x16x32_bf16 v[20:23], a[72:75], a[20:23], v[20:23]
    ds_read_b128 a[116:119], v77 offset:59456
    v_add_f32 v74, v74, v59
    v_mfma_f32_16x16x32_bf16 v[20:23], a[76:79], a[28:31], v[20:23]
    v_mfma_f32_16x16x32_bf16 v[20:23], a[80:83], a[36:39], v[20:23]
    v_exp_f32 v61, v5
    v_mfma_f32_16x16x32_bf16 v[20:23], a[84:87], a[44:47], v[20:23]
    ds_read_b64_tr_b16 a[184:185], v78 offset:17856
    ds_read_b64_tr_b16 a[186:187], v78 offset:26560
    v_mfma_f32_16x16x32_bf16 v[20:23], a[88:91], a[52:55], v[20:23]
    ds_read_b128 a[120:123], v77 offset:59520
    v_add_f32 v75, v60, v61
    v_mfma_f32_16x16x32_bf16 v[20:23], a[92:95], a[60:63], v[20:23]
    v_cvt_pk_bf16_f32 v44, v60, v61
    v_readlane_b32 s82, v92, s52
    s_waitcnt lgkmcnt(15)
    v_mfma_f32_16x16x32_bf16 v[128:131], a[128:131], v[48:51], v[128:131]
    v_exp_f32 v62, v6
    v_mfma_f32_16x16x32_bf16 v[132:135], a[128:131], v[52:55], v[132:135]
    ds_read_b64_tr_b16 a[188:189], v80 offset:17888
    ds_read_b64_tr_b16 a[190:191], v80 offset:26592
    v_mfma_f32_16x16x32_bf16 v[136:139], a[132:135], v[48:51], v[136:139]
    ds_read_b128 a[124:127], v77 offset:59584
    v_add_f32 v75, v75, v62
    v_mfma_f32_16x16x32_bf16 v[140:143], a[132:135], v[52:55], v[140:143]
    s_add_u32 s52, s52, 1
    s_waitcnt vmcnt(10)
    s_barrier
    v_mfma_f32_16x16x32_bf16 v[144:147], a[136:139], v[48:51], v[144:147]
    v_exp_f32 v63, v7
    v_mfma_f32_16x16x32_bf16 v[148:151], a[136:139], v[52:55], v[148:151]
    ds_read_b64_tr_b16 a[128:129], v79 offset:0
    ds_read_b64_tr_b16 a[130:131], v79 offset:8704
    v_mfma_f32_16x16x32_bf16 v[152:155], a[140:143], v[48:51], v[152:155]
    ds_read_b128 a[64:67], v77 offset:0
    s_add_u32 m0, s46, 33792
    v_add_f32 v75, v75, v63
    v_mfma_f32_16x16x32_bf16 v[156:159], a[140:143], v[52:55], v[156:159]
    buffer_load_dwordx4 v84, s[24:27], s82 offen lds
    v_cvt_pk_bf16_f32 v45, v62, v63
    v_mfma_f32_16x16x32_bf16 v[160:163], a[144:147], v[48:51], v[160:163]
    v_exp_f32 v64, v8
    v_mfma_f32_16x16x32_bf16 v[164:167], a[144:147], v[52:55], v[164:167]
    ds_read_b64_tr_b16 a[132:133], v81 offset:32
    ds_read_b64_tr_b16 a[134:135], v81 offset:8736
    v_mfma_f32_16x16x32_bf16 v[168:171], a[148:151], v[48:51], v[168:171]
    ds_read_b128 a[68:71], v77 offset:64
    v_add_f32 v74, v74, v64
    v_mfma_f32_16x16x32_bf16 v[172:175], a[148:151], v[52:55], v[172:175]
    buffer_load_dwordx4 v85, s[24:27], s82 offen offset:1056 lds
    v_mfma_f32_16x16x32_bf16 v[176:179], a[152:155], v[48:51], v[176:179]
    v_exp_f32 v65, v9
    v_mfma_f32_16x16x32_bf16 v[180:183], a[152:155], v[52:55], v[180:183]
    ds_read_b64_tr_b16 a[136:137], v79 offset:64
    ds_read_b64_tr_b16 a[138:139], v79 offset:8768
    v_mfma_f32_16x16x32_bf16 v[184:187], a[156:159], v[48:51], v[184:187]
    ds_read_b128 a[72:75], v77 offset:128
    v_add_f32 v74, v74, v65
    v_mfma_f32_16x16x32_bf16 v[188:191], a[156:159], v[52:55], v[188:191]
    buffer_load_dwordx4 v86, s[24:27], s82 offen offset:2112 lds
    v_cvt_pk_bf16_f32 v42, v64, v65
    s_waitcnt lgkmcnt(9)
    v_mfma_f32_16x16x32_bf16 v[24:27], a[96:99], a[0:3], v[32:35]
    v_exp_f32 v66, v10
    v_mfma_f32_16x16x32_bf16 v[24:27], a[100:103], a[8:11], v[24:27]
    ds_read_b64_tr_b16 a[140:141], v81 offset:96
    ds_read_b64_tr_b16 a[142:143], v81 offset:8800
    v_mfma_f32_16x16x32_bf16 v[24:27], a[104:107], a[16:19], v[24:27]
    ds_read_b128 a[76:79], v77 offset:192
    v_add_f32 v74, v74, v66
    v_mfma_f32_16x16x32_bf16 v[24:27], a[108:111], a[24:27], v[24:27]
    buffer_load_dwordx4 v87, s[24:27], s82 offen offset:3168 lds
    v_mfma_f32_16x16x32_bf16 v[24:27], a[112:115], a[32:35], v[24:27]
    v_exp_f32 v67, v11
    v_mfma_f32_16x16x32_bf16 v[24:27], a[116:119], a[40:43], v[24:27]
    ds_read_b64_tr_b16 a[144:145], v79 offset:128
    ds_read_b64_tr_b16 a[146:147], v79 offset:8832
    v_mfma_f32_16x16x32_bf16 v[24:27], a[120:123], a[48:51], v[24:27]
    ds_read_b128 a[80:83], v77 offset:256
    v_add_f32 v74, v74, v67
    v_mfma_f32_16x16x32_bf16 v[24:27], a[124:127], a[56:59], v[24:27]
    v_cvt_pk_bf16_f32 v43, v66, v67
    v_mfma_f32_16x16x32_bf16 v[28:31], a[96:99], a[4:7], v[36:39]
    v_exp_f32 v68, v12
    v_mfma_f32_16x16x32_bf16 v[28:31], a[100:103], a[12:15], v[28:31]
    ds_read_b64_tr_b16 a[148:149], v81 offset:160
    ds_read_b64_tr_b16 a[150:151], v81 offset:8864
    v_mfma_f32_16x16x32_bf16 v[28:31], a[104:107], a[20:23], v[28:31]
    ds_read_b128 a[84:87], v77 offset:320
    s_add_u32 m0, s47, 0
    v_add_f32 v75, v75, v68
    v_mfma_f32_16x16x32_bf16 v[28:31], a[108:111], a[28:31], v[28:31]
    buffer_load_dwordx4 v88, s[28:31], s80 offen lds
    v_mfma_f32_16x16x32_bf16 v[28:31], a[112:115], a[36:39], v[28:31]
    v_exp_f32 v69, v13
    v_mfma_f32_16x16x32_bf16 v[28:31], a[116:119], a[44:47], v[28:31]
    ds_read_b64_tr_b16 a[152:153], v79 offset:192
    ds_read_b64_tr_b16 a[154:155], v79 offset:8896
    v_mfma_f32_16x16x32_bf16 v[28:31], a[120:123], a[52:55], v[28:31]
    ds_read_b128 a[88:91], v77 offset:384
    v_add_f32 v75, v75, v69
    v_mfma_f32_16x16x32_bf16 v[28:31], a[124:127], a[60:63], v[28:31]
    v_cvt_pk_bf16_f32 v46, v68, v69
    s_waitcnt lgkmcnt(15)
    v_mfma_f32_16x16x32_bf16 v[192:195], a[160:163], v[48:51], v[192:195]
    v_exp_f32 v70, v14
    v_mfma_f32_16x16x32_bf16 v[196:199], a[160:163], v[52:55], v[196:199]
    ds_read_b64_tr_b16 a[156:157], v81 offset:224
    ds_read_b64_tr_b16 a[158:159], v81 offset:8928
    v_mfma_f32_16x16x32_bf16 v[200:203], a[164:167], v[48:51], v[200:203]
    ds_read_b128 a[92:95], v77 offset:448
    v_add_f32 v75, v75, v70
    v_mfma_f32_16x16x32_bf16 v[204:207], a[164:167], v[52:55], v[204:207]
    buffer_load_dwordx4 v89, s[28:31], s80 offen offset:1088 lds
    v_mfma_f32_16x16x32_bf16 v[208:211], a[168:171], v[48:51], v[208:211]
    v_exp_f32 v71, v15
    v_mfma_f32_16x16x32_bf16 v[212:215], a[168:171], v[52:55], v[212:215]
    ds_read_b64_tr_b16 a[160:161], v79 offset:256
    ds_read_b64_tr_b16 a[162:163], v79 offset:8960
    v_mfma_f32_16x16x32_bf16 v[216:219], a[172:175], v[48:51], v[216:219]
    ds_read_b128 a[96:99], v77 offset:8448
    v_add_f32 v75, v75, v71
    v_mfma_f32_16x16x32_bf16 v[220:223], a[172:175], v[52:55], v[220:223]
    buffer_load_dwordx4 v90, s[28:31], s80 offen offset:2176 lds
    v_cvt_pk_bf16_f32 v47, v70, v71
    v_max_f32 v76, v74, v75
    v_mfma_f32_16x16x32_bf16 v[224:227], a[176:179], v[48:51], v[224:227]
    v_exp_f32 v56, v16
    v_mfma_f32_16x16x32_bf16 v[228:231], a[176:179], v[52:55], v[228:231]
    ds_read_b64_tr_b16 a[164:165], v81 offset:288
    ds_read_b64_tr_b16 a[166:167], v81 offset:8992
    v_mfma_f32_16x16x32_bf16 v[232:235], a[180:183], v[48:51], v[232:235]
    ds_read_b128 a[100:103], v77 offset:8512
    v_cmp_lt_f32 vcc, s51, v76
    v_mfma_f32_16x16x32_bf16 v[236:239], a[180:183], v[52:55], v[236:239]
    buffer_load_dwordx4 v91, s[28:31], s80 offen offset:3264 lds
    v_mfma_f32_16x16x32_bf16 v[240:243], a[184:187], v[48:51], v[240:243]
    v_exp_f32 v57, v17
    v_mfma_f32_16x16x32_bf16 v[244:247], a[184:187], v[52:55], v[244:247]
    ds_read_b64_tr_b16 a[168:169], v79 offset:320
    ds_read_b64_tr_b16 a[170:171], v79 offset:9024
    v_mfma_f32_16x16x32_bf16 v[248:251], a[188:191], v[48:51], v[248:251]
    ds_read_b128 a[104:107], v77 offset:8576
    v_mfma_f32_16x16x32_bf16 v[252:255], a[188:191], v[52:55], v[252:255]
    s_cbranch_vccnz L_rare1
L_back1:
    v_add_f32 v72, v72, v74
    v_add_f32 v73, v73, v75
    s_cmp_eq_u32 s52, s53
    s_cbranch_scc1 L_tailA2
L_ph2:
    s_waitcnt lgkmcnt(9)
    v_mfma_f32_16x16x32_bf16 v[0:3], a[64:67], a[0:3], v[32:35]
    v_exp_f32 v58, v18
    v_mfma_f32_16x16x32_bf16 v[0:3], a[68:71], a[8:11], v[0:3]
    ds_read_b64_tr_b16 a[172:173], v81 offset:352
    ds_read_b64_tr_b16 a[174:175], v81 offset:9056
    v_mfma_f32_16x16x32_bf16 v[0:3], a[72:75], a[16:19], v[0:3]
    ds_read_b128 a[108:111], v77 offset:8640
    v_add_f32 v74, v56, v57
    v_mfma_f32_16x16x32_bf16 v[0:3], a[76:79], a[24:27], v[0:3]
    v_cvt_pk_bf16_f32 v48, v56, v57
    v_mfma_f32_16x16x32_bf16 v[0:3], a[80:83], a[32:35], v[0:3]
    v_exp_f32 v59, v19
    v_mfma_f32_16x16x32_bf16 v[0:3], a[84:87], a[40:43], v[0:3]
    ds_read_b64_tr_b16 a[176:177], v79 offset:384
    ds_read_b64_tr_b16 a[178:179], v79 offset:9088
    v_mfma_f32_16x16x32_bf16 v[0:3], a[88:91], a[48:51], v[0:3]
    ds_read_b128 a[112:115], v77 offset:8704
    v_add_f32 v74, v74, v58
    v_mfma_f32_16x16x32_bf16 v[0:3], a[92:95], a[56:59], v[0:3]
    v_cvt_pk_bf16_f32 v49, v58, v59
    v_mfma_f32_16x16x32_bf16 v[4:7], a[64:67], a[4:7], v[36:39]
    v_exp_f32 v60, v20
    v_mfma_f32_16x16x32_bf16 v[4:7], a[68:71], a[12:15], v[4:7]
    ds_read_b64_tr_b16 a[180:181], v81 offset:416
    ds_read_b64_tr_b16 a[182:183], v81 offset:9120
    v_mfma_f32_16x16x32_bf16 v[4:7], a[72:75], a[20:23], v[4:7]
    ds_read_b128 a[116:119], v77 offset:8768
    v_add_f32 v74, v74, v59
    v_mfma_f32_16x16x32_bf16 v[4:7], a[76:79], a[28:31], v[4:7]
    v_mfma_f32_16x16x32_bf16 v[4:7], a[80:83], a[36:39], v[4:7]
    v_exp_f32 v61, v21
    v_mfma_f32_16x16x32_bf16 v[4:7], a[84:87], a[44:47], v[4:7]
    ds_read_b64_tr_b16 a[184:185], v79 offset:448
    ds_read_b64_tr_b16 a[186:187], v79 offset:9152
    v_mfma_f32_16x16x32_bf16 v[4:7], a[88:91], a[52:55], v[4:7]
    ds_read_b128 a[120:123], v77 offset:8832
    v_add_f32 v75, v60, v61
    v_mfma_f32_16x16x32_bf16 v[4:7], a[92:95], a[60:63], v[4:7]
    v_cvt_pk_bf16_f32 v52, v60, v61
    v_readlane_b32 s83, v92, s52
    s_waitcnt lgkmcnt(15)
    v_mfma_f32_16x16x32_bf16 v[128:131], a[128:131], v[40:43], v[128:131]
    v_exp_f32 v62, v22
    v_mfma_f32_16x16x32_bf16 v[132:135], a[128:131], v[44:47], v[132:135]
    ds_read_b64_tr_b16 a[188:189], v81 offset:480
    ds_read_b64_tr_b16 a[190:191], v81 offset:9184
    v_mfma_f32_16x16x32_bf16 v[136:139], a[132:135], v[40:43], v[136:139]
    ds_read_b128 a[124:127], v77 offset:8896
    v_add_f32 v75, v75, v62
    v_mfma_f32_16x16x32_bf16 v[140:143], a[132:135], v[44:47], v[140:143]
    s_add_u32 s52, s52, 1
    s_waitcnt vmcnt(8)
    s_barrier
    v_mfma_f32_16x16x32_bf16 v[144:147], a[136:139], v[40:43], v[144:147]
    v_exp_f32 v63, v23
    v_mfma_f32_16x16x32_bf16 v[148:151], a[136:139], v[44:47], v[148:151]
    ds_read_b64_tr_b16 a[128:129], v79 offset:17408
    ds_read_b64_tr_b16 a[130:131], v79 offset:26112
    v_mfma_f32_16x16x32_bf16 v[152:155], a[140:143], v[40:43], v[152:155]
    ds_read_b128 a[64:67], v77 offset:16896
    s_add_u32 m0, s46, 50688
    v_add_f32 v75, v75, v63
    v_mfma_f32_16x16x32_bf16 v[156:159], a[140:143], v[44:47], v[156:159]
    buffer_load_dwordx4 v84, s[24:27], s83 offen lds
    v_cvt_pk_bf16_f32 v53, v62, v63
    v_mfma_f32_16x16x32_bf16 v[160:163], a[144:147], v[40:43], v[160:163]
    v_exp_f32 v64, v24
    v_mfma_f32_16x16x32_bf16 v[164:167], a[144:147], v[44:47], v[164:167]
    ds_read_b64_tr_b16 a[132:133], v81 offset:17440
    ds_read_b64_tr_b16 a[134:135], v81 offset:26144
    v_mfma_f32_16x16x32_bf16 v[168:171], a[148:151], v[40:43], v[168:171]
    ds_read_b128 a[68:71], v77 offset:16960
    v_add_f32 v74, v74, v64
    v_mfma_f32_16x16x32_bf16 v[172:175], a[148:151], v[44:47], v[172:175]
    buffer_load_dwordx4 v85, s[24:27], s83 offen offset:1056 lds
    v_mfma_f32_16x16x32_bf16 v[176:179], a[152:155], v[40:43], v[176:179]
    v_exp_f32 v65, v25
    v_mfma_f32_16x16x32_bf16 v[180:183], a[152:155], v[44:47], v[180:183]
    ds_read_b64_tr_b16 a[136:137], v79 offset:17472
    ds_read_b64_tr_b16 a[138:139], v79 offset:26176
    v_mfma_f32_16x16x32_bf16 v[184:187], a[156:159], v[40:43], v[184:187]
    ds_read_b128 a[72:75], v77 offset:17024
    v_add_f32 v74, v74, v65
    v_mfma_f32_16x16x32_bf16 v[188:191], a[156:159], v[44:47], v[188:191]
    buffer_load_dwordx4 v86, s[24:27], s83 offen offset:2112 lds
    v_cvt_pk_bf16_f32 v50, v64, v65
    s_waitcnt lgkmcnt(9)
    v_mfma_f32_16x16x32_bf16 v[8:11], a[96:99], a[0:3], v[32:35]
    v_exp_f32 v66, v26
    v_mfma_f32_16x16x32_bf16 v[8:11], a[100:103], a[8:11], v[8:11]
    ds_read_b64_tr_b16 a[140:141], v81 offset:17504
    ds_read_b64_tr_b16 a[142:143], v81 offset:26208
    v_mfma_f32_16x16x32_bf16 v[8:11], a[104:107], a[16:19], v[8:11]
    ds_read_b128 a[76:79], v77 offset:17088
    v_add_f32 v74, v74, v66
    v_mfma_f32_16x16x32_bf16 v[8:11], a[108:111], a[24:27], v[8:11]
    buffer_load_dwordx4 v87, s[24:27], s83 offen offset:3168 lds
    v_mfma_f32_16x16x32_bf16 v[8:11], a[112:115], a[32:35], v[8:11]
    v_exp_f32 v67, v27
    v_mfma_f32_16x16x32_bf16 v[8:11], a[116:119], a[40:43], v[8:11]
    ds_read_b64_tr_b16 a[144:145], v79 offset:17536
    ds_read_b64_tr_b16 a[146:147], v79 offset:26240
    v_mfma_f32_16x16x32_bf16 v[8:11], a[120:123], a[48:51], v[8:11]
    ds_read_b128 a[80:83], v77 offset:17152
    v_add_f32 v74, v74, v67
    v_mfma_f32_16x16x32_bf16 v[8:11], a[124:127], a[56:59], v[8:11]
    v_cvt_pk_bf16_f32 v51, v66, v67
    v_mfma_f32_16x16x32_bf16 v[12:15], a[96:99], a[4:7], v[36:39]
    v_exp_f32 v68, v28
    v_mfma_f32_16x16x32_bf16 v[12:15], a[100:103], a[12:15], v[12:15]
    ds_read_b64_tr_b16 a[148:149], v81 offset:17568
    ds_read_b64_tr_b16 a[150:151], v81 offset:26272
    v_mfma_f32_16x16x32_bf16 v[12:15], a[104:107], a[20:23], v[12:15]
    ds_read_b128 a[84:87], v77 offset:17216
    s_add_u32 m0, s47, 17408
    v_add_f32 v75, v75, v68
    v_mfma_f32_16x16x32_bf16 v[12:15], a[108:111], a[28:31], v[12:15]
    buffer_load_dwordx4 v88, s[28:31], s81 offen lds
    v_mfma_f32_16x16x32_bf16 v[12:15], a[112:115], a[36:39], v[12:15]
    v_exp_f32 v69, v29
    v_mfma_f32_16x16x32_bf16 v[12:15], a[116:119], a[44:47], v[12:15]
    ds_read_b64_tr_b16 a[152:153], v79 offset:17600
    ds_read_b64_tr_b16 a[154:155], v79 offset:26304
    v_mfma_f32_16x16x32_bf16 v[12:15], a[120:123], a[52:55], v[12:15]
    ds_read_b128 a[88:91], v77 offset:17280
    v_add_f32 v75, v75, v69
    v_mfma_f32_16x16x32_bf16 v[12:15], a[124:127], a[60:63], v[12:15]
    v_cvt_pk_bf16_f32 v54, v68, v69
    s_waitcnt lgkmcnt(15)
    v_mfma_f32_16x16x32_bf16 v[192:195], a[160:163], v[40:43], v[192:195]
    v_exp_f32 v70, v30
    v_mfma_f32_16x16x32_bf16 v[196:199], a[160:163], v[44:47], v[196:199]
    ds_read_b64_tr_b16 a[156:157], v81 offset:17632
    ds_read_b64_tr_b16 a[158:159], v81 offset:26336
    v_mfma_f32_16x16x32_bf16 v[200:203], a[164:167], v[40:43], v[200:203]
    ds_read_b128 a[92:95], v77 offset:17344
    v_add_f32 v75, v75, v70
    v_mfma_f32_16x16x32_bf16 v[204:207], a[164:167], v[44:47], v[204:207]
    buffer_load_dwordx4 v89, s[28:31], s81 offen offset:1088 lds
    v_mfma_f32_16x16x32_bf16 v[208:211], a[168:171], v[40:43], v[208:211]
    v_exp_f32 v71, v31
    v_mfma_f32_16x16x32_bf16 v[212:215], a[168:171], v[44:47], v[212:215]
    ds_read_b64_tr_b16 a[160:161], v79 offset:17664
    ds_read_b64_tr_b16 a[162:163], v79 offset:26368
    v_mfma_f32_16x16x32_bf16 v[216:219], a[172:175], v[40:43], v[216:219]
    ds_read_b128 a[96:99], v77 offset:25344
    v_add_f32 v75, v75, v71
    v_mfma_f32_16x16x32_bf16 v[220:223], a[172:175], v[44:47], v[220:223]
    buffer_load_dwordx4 v90, s[28:31], s81 offen offset:2176 lds
    v_cvt_pk_bf16_f32 v55, v70, v71
    v_max_f32 v76, v74, v75
    v_mfma_f32_16x16x32_bf16 v[224:227], a[176:179], v[40:43], v[224:227]
    v_exp_f32 v56, v0
    v_mfma_f32_16x16x32_bf16 v[228:231], a[176:179], v[44:47], v[228:231]
    ds_read_b64_tr_b16 a[164:165], v81 offset:17696
    ds_read_b64_tr_b16 a[166:167], v81 offset:26400
    v_mfma_f32_16x16x32_bf16 v[232:235], a[180:183], v[40:43], v[232:235]
    ds_read_b128 a[100:103], v77 offset:25408
    v_cmp_lt_f32 vcc, s51, v76
    v_mfma_f32_16x16x32_bf16 v[236:239], a[180:183], v[44:47], v[236:239]
    buffer_load_dwordx4 v91, s[28:31], s81 offen offset:3264 lds
    v_mfma_f32_16x16x32_bf16 v[240:243], a[184:187], v[40:43], v[240:243]
    v_exp_f32 v57, v1
    v_mfma_f32_16x16x32_bf16 v[244:247], a[184:187], v[44:47], v[244:247]
    ds_read_b64_tr_b16 a[168:169], v79 offset:17728
    ds_read_b64_tr_b16 a[170:171], v79 offset:26432
    v_mfma_f32_16x16x32_bf16 v[248:251], a[188:191], v[40:43], v[248:251]
    ds_read_b128 a[104:107], v77 offset:25472
    v_mfma_f32_16x16x32_bf16 v[252:255], a[188:191], v[44:47], v[252:255]
    s_cbranch_vccnz L_rare2
L_back2:
    v_add_f32 v72, v72, v74
    v_add_f32 v73, v73, v75
    s_cmp_eq_u32 s52, s53
    s_cbranch_scc1 L_tailA3
L_ph3:
    s_waitcnt lgkmcnt(9)
    v_mfma_f32_16x16x32_bf16 v[16:19], a[64:67], a[0:3], v[32:35]
    v_exp_f32 v58, v2
    v_mfma_f32_16x16x32_bf16 v[16:19], a[68:71], a[8:11], v[16:19]
    ds_read_b64_tr_b16 a[172:173], v81 offset:17760
    ds_read_b64_tr_b16 a[174:175], v81 offset:26464
    v_mfma_f32_16x16x32_bf16 v[16:19], a[72:75], a[16:19], v[16:19]
    ds_read_b128 a[108:111], v77 offset:25536
    v_add_f32 v74, v56, v57
    v_mfma_f32_16x16x32_bf16 v[16:19], a[76:79], a[24:27], v[16:19]
    v_cvt_pk_bf16_f32 v40, v56, v57
    v_mfma_f32_16x16x32_bf16 v[16:19], a[80:83], a[32:35], v[16:19]
    v_exp_f32 v59, v3
    v_mfma_f32_16x16x32_bf16 v[16:19], a[84:87], a[40:43], v[16:19]
    ds_read_b64_tr_b16 a[176:177], v79 offset:17792
    ds_read_b64_tr_b16 a[178:179], v79 offset:26496
    v_mfma_f32_16x16x32_bf16 v[16:19], a[88:91], a[48:51], v[16:19]
    ds_read_b128 a[112:115], v77 offset:25600
    v_add_f32 v74, v74, v58
    v_mfma_f32_16x16x32_bf16 v[16:19], a[92:95], a[56:59], v[16:19]
    v_cvt_pk_bf16_f32 v41, v58, v59
    v_mfma_f32_16x16x32_bf16 v[20:23], a[64:67], a[4:7], v[36:39]
    v_exp_f32 v60, v4
    v_mfma_f32_16x16x32_bf16 v[20:23], a[68:71], a[12:15], v[20:23]
    ds_read_b64_tr_b16 a[180:181], v81 offset:17824
    ds_read_b64_tr_b16 a[182:183], v81 offset:26528
    v_mfma_f32_16x16x32_bf16 v[20:23], a[72:75], a[20:23], v[20:23]
    ds_read_b128 a[116:119], v77 offset:25664
    v_add_f32 v74, v74, v59
    v_mfma_f32_16x16x32_bf16 v[20:23], a[76:79], a[28:31], v[20:23]
    v_mfma_f32_16x16x32_bf16 v[20:23], a[80:83], a[36:39], v[20:23]
    v_exp_f32 v61, v5
    v_mfma_f32_16x16x32_bf16 v[20:23], a[84:87], a[44:47], v[20:23]
    ds_read_b64_tr_b16 a[184:185], v79 offset:17856
    ds_read_b64_tr_b16 a[186:187], v79 offset:26560
    v_mfma_f32_16x16x32_bf16 v[20:23], a[88:91], a[52:55], v[20:23]
    ds_read_b128 a[120:123], v77 offset:25728
    v_add_f32 v75, v60, v61
    v_mfma_f32_16x16x32_bf16 v[20:23], a[92:95], a[60:63], v[20:23]
    v_cvt_pk_bf16_f32 v44, v60, v61
    v_readlane_b32 s80, v92, s52
    s_waitcnt lgkmcnt(15)
    v_mfma_f32_16x16x32_bf16 v[128:131], a[128:131], v[48:51], v[128:131]
    v_exp_f32 v62, v6
    v_mfma_f32_16x16x32_bf16 v[132:135], a[128:131], v[52:55], v[132:135]
    ds_read_b64_tr_b16 a[188:189], v81 offset:17888
    ds_read_b64_tr_b16 a[190:191], v81 offset:26592
    v_mfma_f32_16x16x32_bf16 v[136:139], a[132:135], v[48:51], v[136:139]
    ds_read_b128 a[124:127], v77 offset:25792
    v_add_f32 v75, v75, v62
    v_mfma_f32_16x16x32_bf16 v[140:143], a[132:135], v[52:55], v[140:143]
    s_add_u32 s52, s52, 1
    s_waitcnt vmcnt(8)
    s_barrier
    v_mfma_f32_16x16x32_bf16 v[144:147], a[136:139], v[48:51], v[144:147]
    v_exp_f32 v63, v7
    v_mfma_f32_16x16x32_bf16 v[148:151], a[136:139], v[52:55], v[148:151]
    ds_read_b64_tr_b16 a[128:129], v78 offset:0
    ds_read_b64_tr_b16 a[130:131], v78 offset:8704
    v_mfma_f32_16x16x32_bf16 v[152:155], a[140:143], v[48:51], v[152:155]
    ds_read_b128 a[64:67], v77 offset:33792
    s_add_u32 m0, s46, 0
    v_add_f32 v75, v75, v63
    v_mfma_f32_16x16x32_bf16 v[156:159], a[140:143], v[52:55], v[156:159]
    buffer_load_dwordx4 v84, s[24:27], s80 offen lds
    v_cvt_pk_bf16_f32 v45, v62, v63
    v_mfma_f32_16x16x32_bf16 v[160:163], a[144:147], v[48:51], v[160:163]
    v_exp_f32 v64, v8
    v_mfma_f32_16x16x32_bf16 v[164:167], a[144:147], v[52:55], v[164:167]
    ds_read_b64_tr_b16 a[132:133], v80 offset:32
    ds_read_b64_tr_b16 a[134:135], v80 offset:8736
    v_mfma_f32_16x16x32_bf16 v[168:171], a[148:151], v[48:51], v[168:171]
    ds_read_b128 a[68:71], v77 offset:33856
    v_add_f32 v74, v74, v64
    v_mfma_f32_16x16x32_bf16 v[172:175], a[148:151], v[52:55], v[172:175]
    buffer_load_dwordx4 v85, s[24:27], s80 offen offset:1056 lds
    v_mfma_f32_16x16x32_bf16 v[176:179], a[152:155], v[48:51], v[176:179]
    v_exp_f32 v65, v9
    v_mfma_f32_16x16x32_bf16 v[180:183], a[152:155], v[52:55], v[180:183]
    ds_read_b64_tr_b16 a[136:137], v78 offset:64
    ds_read_b64_tr_b16 a[138:139], v78 offset:8768
    v_mfma_f32_16x16x32_bf16 v[184:187], a[156:159], v[48:51], v[184:187]
    ds_read_b128 a[72:75], v77 offset:33920
    v_add_f32 v74, v74, v65
    v_mfma_f32_16x16x32_bf16 v[188:191], a[156:159], v[52:55], v[188:191]
    buffer_load_dwordx4 v86, s[24:27], s80 offen offset:2112 lds
    v_cvt_pk_bf16_f32 v42, v64, v65
    s_waitcnt lgkmcnt(9)
    v_mfma_f32_16x16x32_bf16 v[24:27], a[96:99], a[0:3], v[32:35]
    v_exp_f32 v66, v10
    v_mfma_f32_16x16x32_bf16 v[24:27], a[100:103], a[8:11], v[24:27]
    ds_read_b64_tr_b16 a[140:141], v80 offset:96
    ds_read_b64_tr_b16 a[142:143], v80 offset:8800
    v_mfma_f32_16x16x32_bf16 v[24:27], a[104:107], a[16:19], v[24:27]
    ds_read_b128 a[76:79], v77 offset:33984
    v_add_f32 v74, v74, v66
    v_mfma_f32_16x16x32_bf16 v[24:27], a[108:111], a[24:27], v[24:27]
    buffer_load_dwordx4 v87, s[24:27], s80 offen offset:3168 lds
    v_mfma_f32_16x16x32_bf16 v[24:27], a[112:115], a[32:35], v[24:27]
    v_exp_f32 v67, v11
    v_mfma_f32_16x16x32_bf16 v[24:27], a[116:119], a[40:43], v[24:27]
    ds_read_b64_tr_b16 a[144:145], v78 offset:128
    ds_read_b64_tr_b16 a[146:147], v78 offset:8832
    v_mfma_f32_16x16x32_bf16 v[24:27], a[120:123], a[48:51], v[24:27]
    ds_read_b128 a[80:83], v77 offset:34048
    v_add_f32 v74, v74, v67
    v_mfma_f32_16x16x32_bf16 v[24:27], a[124:127], a[56:59], v[24:27]
    v_cvt_pk_bf16_f32 v43, v66, v67
    v_mfma_f32_16x16x32_bf16 v[28:31], a[96:99], a[4:7], v[36:39]
    v_exp_f32 v68, v12
    v_mfma_f32_16x16x32_bf16 v[28:31], a[100:103], a[12:15], v[28:31]
    ds_read_b64_tr_b16 a[148:149], v80 offset:160
    ds_read_b64_tr_b16 a[150:151], v80 offset:8864
    v_mfma_f32_16x16x32_bf16 v[28:31], a[104:107], a[20:23], v[28:31]
    ds_read_b128 a[84:87], v77 offset:34112
    s_add_u32 m0, s47, 34816
    v_add_f32 v75, v75, v68
    v_mfma_f32_16x16x32_bf16 v[28:31], a[108:111], a[28:31], v[28:31]
    buffer_load_dwordx4 v88, s[28:31], s82 offen lds
    v_mfma_f32_16x16x32_bf16 v[28:31], a[112:115], a[36:39], v[28:31]
    v_exp_f32 v69, v13
    v_mfma_f32_16x16x32_bf16 v[28:31], a[116:119], a[44:47], v[28:31]
    ds_read_b64_tr_b16 a[152:153], v78 offset:192
    ds_read_b64_tr_b16 a[154:155], v78 offset:8896
    v_mfma_f32_16x16x32_bf16 v[28:31], a[120:123], a[52:55], v[28:31]
    ds_read_b128 a[88:91], v77 offset:34176
    v_add_f32 v75, v75, v69
    v_mfma_f32_16x16x32_bf16 v[28:31], a[124:127], a[60:63], v[28:31]
    v_cvt_pk_bf16_f32 v46, v68, v69
    s_waitcnt lgkmcnt(15)
    v_mfma_f32_16x16x32_bf16 v[192:195], a[160:163], v[48:51], v[192:195]
    v_exp_f32 v70, v14
    v_mfma_f32_16x16x32_bf16 v[196:199], a[160:163], v[52:55], v[196:199]
    ds_read_b64_tr_b16 a[156:157], v80 offset:224
    ds_read_b64_tr_b16 a[158:159], v80 offset:8928
    v_mfma_f32_16x16x32_bf16 v[200:203], a[164:167], v[48:51], v[200:203]
    ds_read_b128 a[92:95], v77 offset:34240
    v_add_f32 v75, v75, v70
    v_mfma_f32_16x16x32_bf16 v[204:207], a[164:167], v[52:55], v[204:207]
    buffer_load_dwordx4 v89, s[28:31], s82 offen offset:1088 lds
    v_mfma_f32_16x16x32_bf16 v[208:211], a[168:171], v[48:51], v[208:211]
    v_exp_f32 v71, v15
    v_mfma_f32_16x16x32_bf16 v[212:215], a[168:171], v[52:55], v[212:215]
    ds_read_b64_tr_b16 a[160:161], v78 offset:256
    ds_read_b64_tr_b16 a[162:163], v78 offset:8960
    v_mfma_f32_16x16x32_bf16 v[216:219], a[172:175], v[48:51], v[216:219]
    ds_read_b128 a[96:99], v77 offset:42240
    v_add_f32 v75, v75, v71
    v_mfma_f32_16x16x32_bf16 v[220:223], a[172:175], v[52:55], v[220:223]
    buffer_load_dwordx4 v90, s[28:31], s82 offen offset:2176 lds
    v_cvt_pk_bf16_f32 v47, v70, v71
    v_max_f32 v76, v74, v75
    v_mfma_f32_16x16x32_bf16 v[224:227], a[176:179], v[48:51], v[224:227]
    v_exp_f32 v56, v16
    v_mfma_f32_16x16x32_bf16 v[228:231], a[176:179], v[52:55], v[228:231]
    ds_read_b64_tr_b16 a[164:165], v80 offset:288
    ds_read_b64_tr_b16 a[166:167], v80 offset:8992
    v_mfma_f32_16x16x32_bf16 v[232:235], a[180:183], v[48:51], v[232:235]
    ds_read_b128 a[100:103], v77 offset:42304
    v_cmp_lt_f32 vcc, s51, v76
    v_mfma_f32_16x16x32_bf16 v[236:239], a[180:183], v[52:55], v[236:239]
    buffer_load_dwordx4 v91, s[28:31], s82 offen offset:3264 lds
    v_mfma_f32_16x16x32_bf16 v[240:243], a[184:187], v[48:51], v[240:243]
    v_exp_f32 v57, v17
    v_mfma_f32_16x16x32_bf16 v[244:247], a[184:187], v[52:55], v[244:247]
    ds_read_b64_tr_b16 a[168:169], v78 offset:320
    ds_read_b64_tr_b16 a[170:171], v78 offset:9024
    v_mfma_f32_16x16x32_bf16 v[248:251], a[188:191], v[48:51], v[248:251]
    ds_read_b128 a[104:107], v77 offset:42368
    v_mfma_f32_16x16x32_bf16 v[252:255], a[188:191], v[52:55], v[252:255]
    s_cbranch_vccnz L_rare3
L_back3:
    v_add_f32 v72, v72, v74
    v_add_f32 v73, v73, v75
    s_cmp_eq_u32 s52, s53
    s_cbranch_scc0 L_ph0
L_tailA0:
    ds_read_b64_tr_b16 a[172:173], v80 offset:352
    ds_read_b64_tr_b16 a[174:175], v80 offset:9056
    ds_read_b64_tr_b16 a[176:177], v78 offset:384
    ds_read_b64_tr_b16 a[178:179], v78 offset:9088
    ds_read_b64_tr_b16 a[180:181], v80 offset:416
    ds_read_b64_tr_b16 a[182:183], v80 offset:9120
    ds_read_b64_tr_b16 a[184:185], v78 offset:448
    ds_read_b64_tr_b16 a[186:187], v78 offset:9152
    s_waitcnt lgkmcnt(14)
    v_mfma_f32_16x16x32_bf16 v[128:131], a[128:131], v[40:43], v[128:131]
    s_lshl_b32 s56, s41, 5
    s_sub_u32 s56, s40, s56
    s_add_u32 s56, s56, 32
    v_mfma_f32_16x16x32_bf16 v[132:135], a[128:131], v[44:47], v[132:135]
    ds_read_b64_tr_b16 a[188:189], v80 offset:480
    ds_read_b64_tr_b16 a[190:191], v80 offset:9184
    v_sub_u32 v98, s56, v96
    s_nop 3
    v_cmp_lt_i32_e64 s[64:65], 0, v98
    v_mfma_f32_16x16x32_bf16 v[136:139], a[132:135], v[40:43], v[136:139]
    v_cmp_lt_i32_e64 s[66:67], 1, v98
    v_cmp_lt_i32_e64 s[68:69], 2, v98
    v_cmp_lt_i32_e64 s[70:71], 3, v98
    v_mfma_f32_16x16x32_bf16 v[140:143], a[132:135], v[44:47], v[140:143]
    s_waitcnt vmcnt(8)
    s_barrier
    v_cmp_lt_i32_e64 s[72:73], 16, v98
    v_cmp_lt_i32_e64 s[74:75], 17, v98
    v_cmp_lt_i32_e64 s[76:77], 18, v98
    v_mfma_f32_16x16x32_bf16 v[144:147], a[136:139], v[40:43], v[144:147]
    v_cmp_lt_i32_e64 s[78:79], 19, v98
    s_nop 1
    v_cndmask_b32_e64 v16, v97, v16, s[64:65]
    v_mfma_f32_16x16x32_bf16 v[148:151], a[136:139], v[44:47], v[148:151]
    ds_read_b64_tr_b16 a[128:129], v78 offset:17408
    ds_read_b64_tr_b16 a[130:131], v78 offset:26112
    v_cndmask_b32_e64 v17, v97, v17, s[66:67]
    v_cndmask_b32_e64 v18, v97, v18, s[68:69]
    v_cndmask_b32_e64 v19, v97, v19, s[70:71]
    v_mfma_f32_16x16x32_bf16 v[152:155], a[140:143], v[40:43], v[152:155]
    v_cndmask_b32_e64 v20, v97, v20, s[64:65]
    v_cndmask_b32_e64 v21, v97, v21, s[66:67]
    v_cndmask_b32_e64 v22, v97, v22, s[68:69]
    v_mfma_f32_16x16x32_bf16 v[156:159], a[140:143], v[44:47], v[156:159]
    v_cndmask_b32_e64 v23, v97, v23, s[70:71]
    v_cndmask_b32_e64 v24, v97, v24, s[72:73]
    v_cndmask_b32_e64 v25, v97, v25, s[74:75]
    v_mfma_f32_16x16x32_bf16 v[160:163], a[144:147], v[40:43], v[160:163]
    v_cndmask_b32_e64 v26, v97, v26, s[76:77]
    v_cndmask_b32_e64 v27, v97, v27, s[78:79]
    v_cndmask_b32_e64 v28, v97, v28, s[72:73]
    v_mfma_f32_16x16x32_bf16 v[164:167], a[144:147], v[44:47], v[164:167]
    ds_read_b64_tr_b16 a[132:133], v80 offset:17440
    ds_read_b64_tr_b16 a[134:135], v80 offset:26144
    v_cndmask_b32_e64 v29, v97, v29, s[74:75]
    v_cndmask_b32_e64 v30, v97, v30, s[76:77]
    v_cndmask_b32_e64 v31, v97, v31, s[78:79]
    v_mfma_f32_16x16x32_bf16 v[168:171], a[148:151], v[40:43], v[168:171]
    v_exp_f32 v56, v16
    v_exp_f32 v57, v17
    v_exp_f32 v58, v18
    v_mfma_f32_16x16x32_bf16 v[172:175], a[148:151], v[44:47], v[172:175]
    v_exp_f32 v59, v19
    v_exp_f32 v60, v20
    v_exp_f32 v61, v21
    v_mfma_f32_16x16x32_bf16 v[176:179], a[152:155], v[40:43], v[176:179]
    v_exp_f32 v62, v22
    v_exp_f32 v63, v23
    v_exp_f32 v64, v24
    v_mfma_f32_16x16x32_bf16 v[180:183], a[152:155], v[44:47], v[180:183]
    ds_read_b64_tr_b16 a[136:137], v78 offset:17472
    ds_read_b64_tr_b16 a[138:139], v78 offset:26176
    v_exp_f32 v65, v25
    v_exp_f32 v66, v26
    v_exp_f32 v67, v27
    v_mfma_f32_16x16x32_bf16 v[184:187], a[156:159], v[40:43], v[184:187]
    v_exp_f32 v68, v28
    v_exp_f32 v69, v29
    v_exp_f32 v70, v30
    v_mfma_f32_16x16x32_bf16 v[188:191], a[156:159], v[44:47], v[188:191]
    v_exp_f32 v71, v31
    v_add_f32 v74, v56, v57
    v_add_f32 v74, v74, v58
    ds_read_b64_tr_b16 a[140:141], v80 offset:17504
    ds_read_b64_tr_b16 a[142:143], v80 offset:26208
    ds_read_b64_tr_b16 a[144:145], v78 offset:17536
    ds_read_b64_tr_b16 a[146:147], v78 offset:26240
    ds_read_b64_tr_b16 a[148:149], v80 offset:17568
    ds_read_b64_tr_b16 a[150:151], v80 offset:26272
    ds_read_b64_tr_b16 a[152:153], v78 offset:17600
    ds_read_b64_tr_b16 a[154:155], v78 offset:26304
    s_waitcnt lgkmcnt(14)
    v_mfma_f32_16x16x32_bf16 v[192:195], a[160:163], v[40:43], v[192:195]
    v_add_f32 v74, v74, v59
    v_add_f32 v75, v60, v61
    v_add_f32 v75, v75, v62
    v_mfma_f32_16x16x32_bf16 v[196:199], a[160:163], v[44:47], v[196:199]
    ds_read_b64_tr_b16 a[156:157], v80 offset:17632
    ds_read_b64_tr_b16 a[158:159], v80 offset:26336
    v_add_f32 v75, v75, v63
    v_add_f32 v74, v74, v64
    v_add_f32 v74, v74, v65
    v_mfma_f32_16x16x32_bf16 v[200:203], a[164:167], v[40:43], v[200:203]
    v_add_f32 v74, v74, v66
    v_add_f32 v74, v74, v67
    v_add_f32 v75, v75, v68
    v_mfma_f32_16x16x32_bf16 v[204:207], a[164:167], v[44:47], v[204:207]
    v_add_f32 v75, v75, v69
    v_add_f32 v75, v75, v70
    v_add_f32 v75, v75, v71
    v_mfma_f32_16x16x32_bf16 v[208:211], a[168:171], v[40:43], v[208:211]
    v_cvt_pk_bf16_f32 v48, v56, v57
    v_cvt_pk_bf16_f32 v49, v58, v59
    v_cvt_pk_bf16_f32 v52, v60, v61
    v_mfma_f32_16x16x32_bf16 v[212:215], a[168:171], v[44:47], v[212:215]
    ds_read_b64_tr_b16 a[160:161], v78 offset:17664
    ds_read_b64_tr_b16 a[162:163], v78 offset:26368
    v_cvt_pk_bf16_f32 v53, v62, v63
    v_cvt_pk_bf16_f32 v50, v64, v65
    v_cvt_pk_bf16_f32 v51, v66, v67
    v_mfma_f32_16x16x32_bf16 v[216:219], a[172:175], v[40:43], v[216:219]
    v_cvt_pk_bf16_f32 v54, v68, v69
    v_cvt_pk_bf16_f32 v55, v70, v71
    v_max_f32 v76, v74, v75
    v_mfma_f32_16x16x32_bf16 v[220:223], a[172:175], v[44:47], v[220:223]
    v_cmp_lt_f32 vcc, s51, v76
    v_mfma_f32_16x16x32_bf16 v[224:227], a[176:179], v[40:43], v[224:227]
    v_mfma_f32_16x16x32_bf16 v[228:231], a[176:179], v[44:47], v[228:231]
    ds_read_b64_tr_b16 a[164:165], v80 offset:17696
    ds_read_b64_tr_b16 a[166:167], v80 offset:26400
    v_mfma_f32_16x16x32_bf16 v[232:235], a[180:183], v[40:43], v[232:235]
    v_mfma_f32_16x16x32_bf16 v[236:239], a[180:183], v[44:47], v[236:239]
    v_mfma_f32_16x16x32_bf16 v[240:243], a[184:187], v[40:43], v[240:243]
    v_mfma_f32_16x16x32_bf16 v[244:247], a[184:187], v[44:47], v[244:247]
    ds_read_b64_tr_b16 a[168:169], v78 offset:17728
    ds_read_b64_tr_b16 a[170:171], v78 offset:26432
    v_mfma_f32_16x16x32_bf16 v[248:251], a[188:191], v[40:43], v[248:251]
    v_mfma_f32_16x16x32_bf16 v[252:255], a[188:191], v[44:47], v[252:255]
    s_cbranch_vccnz L_raret0
L_backt0:
    v_add_f32 v72, v72, v74
    v_add_f32 v73, v73, v75
    s_branch L_tailB1
L_tailA1:
    ds_read_b64_tr_b16 a[172:173], v80 offset:17760
    ds_read_b64_tr_b16 a[174:175], v80 offset:26464
    ds_read_b64_tr_b16 a[176:177], v78 offset:17792
    ds_read_b64_tr_b16 a[178:179], v78 offset:26496
    ds_read_b64_tr_b16 a[180:181], v80 offset:17824
    ds_read_b64_tr_b16 a[182:183], v80 offset:26528
    ds_read_b64_tr_b16 a[184:185], v78 offset:17856
    ds_read_b64_tr_b16 a[186:187], v78 offset:26560
    s_waitcnt lgkmcnt(15)
    v_mfma_f32_16x16x32_bf16 v[128:131], a[128:131], v[48:51], v[128:131]
    s_lshl_b32 s56, s41, 5
    s_sub_u32 s56, s40, s56
    s_add_u32 s56, s56, 32
    v_mfma_f32_16x16x32_bf16 v[132:135], a[128:131], v[52:55], v[132:135]
    ds_read_b64_tr_b16 a[188:189], v80 offset:17888
    ds_read_b64_tr_b16 a[190:191], v80 offset:26592
    v_sub_u32 v98, s56, v96
    s_nop 3
    v_cmp_lt_i32_e64 s[64:65], 0, v98
    v_mfma_f32_16x16x32_bf16 v[136:139], a[132:135], v[48:51], v[136:139]
    v_cmp_lt_i32_e64 s[66:67], 1, v98
    v_cmp_lt_i32_e64 s[68:69], 2, v98
    v_cmp_lt_i32_e64 s[70:71], 3, v98
    v_mfma_f32_16x16x32_bf16 v[140:143], a[132:135], v[52:55], v[140:143]
    s_waitcnt vmcnt(10)
    s_barrier
    v_cmp_lt_i32_e64 s[72:73], 16, v98
    v_cmp_lt_i32_e64 s[74:75], 17, v98
    v_cmp_lt_i32_e64 s[76:77], 18, v98
    v_mfma_f32_16x16x32_bf16 v[144:147], a[136:139], v[48:51], v[144:147]
    v_cmp_lt_i32_e64 s[78:79], 19, v98
    s_nop 1
    v_cndmask_b32_e64 v0, v97, v0, s[64:65]
    v_mfma_f32_16x16x32_bf16 v[148:151], a[136:139], v[52:55], v[148:151]
    ds_read_b64_tr_b16 a[128:129], v79 offset:0
    ds_read_b64_tr_b16 a[130:131], v79 offset:8704
    v_cndmask_b32_e64 v1, v97, v1, s[66:67]
    v_cndmask_b32_e64 v2, v97, v2, s[68:69]
    v_cndmask_b32_e64 v3, v97, v3, s[70:71]
    v_mfma_f32_16x16x32_bf16 v[152:155], a[140:143], v[48:51], v[152:155]
    v_cndmask_b32_e64 v4, v97, v4, s[64:65]
    v_cndmask_b32_e64 v5, v97, v5, s[66:67]
    v_cndmask_b32_e64 v6, v97, v6, s[68:69]
    v_mfma_f32_16x16x32_bf16 v[156:159], a[140:143], v[52:55], v[156:159]
    v_cndmask_b32_e64 v7, v97, v7, s[70:71]
    v_cndmask_b32_e64 v8, v97, v8, s[72:73]
    v_cndmask_b32_e64 v9, v97, v9, s[74:75]
    v_mfma_f32_16x16x32_bf16 v[160:163], a[144:147], v[48:51], v[160:163]
    v_cndmask_b32_e64 v10, v97, v10, s[76:77]
    v_cndmask_b32_e64 v11, v97, v11, s[78:79]
    v_cndmask_b32_e64 v12, v97, v12, s[72:73]
    v_mfma_f32_16x16x32_bf16 v[164:167], a[144:147], v[52:55], v[164:167]
    ds_read_b64_tr_b16 a[132:133], v81 offset:32
    ds_read_b64_tr_b16 a[134:135], v81 offset:8736
    v_cndmask_b32_e64 v13, v97, v13, s[74:75]
    v_cndmask_b32_e64 v14, v97, v14, s[76:77]
    v_cndmask_b32_e64 v15, v97, v15, s[78:79]
    v_mfma_f32_16x16x32_bf16 v[168:171], a[148:151], v[48:51], v[168:171]
    v_exp_f32 v56, v0
    v_exp_f32 v57, v1
    v_exp_f32 v58, v2
    v_mfma_f32_16x16x32_bf16 v[172:175], a[148:151], v[52:55], v[172:175]
    v_exp_f32 v59, v3
    v_exp_f32 v60, v4
    v_exp_f32 v61, v5
    v_mfma_f32_16x16x32_bf16 v[176:179], a[152:155], v[48:51], v[176:179]
    v_exp_f32 v62, v6
    v_exp_f32 v63, v7
    v_exp_f32 v64, v8
    v_mfma_f32_16x16x32_bf16 v[180:183], a[152:155], v[52:55], v[180:183]
    ds_read_b64_tr_b16 a[136:137], v79 offset:64
    ds_read_b64_tr_b16 a[138:139], v79 offset:8768
    v_exp_f32 v65, v9
    v_exp_f32 v66, v10
    v_exp_f32 v67, v11
    v_mfma_f32_16x16x32_bf16 v[184:187], a[156:159], v[48:51], v[184:187]
    v_exp_f32 v68, v12
    v_exp_f32 v69, v13
    v_exp_f32 v70, v14
    v_mfma_f32_16x16x32_bf16 v[188:191], a[156:159], v[52:55], v[188:191]
    v_exp_f32 v71, v15
    v_add_f32 v74, v56, v57
    v_add_f32 v74, v74, v58
    ds_read_b64_tr_b16 a[140:141], v81 offset:96
    ds_read_b64_tr_b16 a[142:143], v81 offset:8800
    ds_read_b64_tr_b16 a[144:145], v79 offset:128
    ds_read_b64_tr_b16 a[146:147], v79 offset:8832
    ds_read_b64_tr_b16 a[148:149], v81 offset:160
    ds_read_b64_tr_b16 a[150:151], v81 offset:8864
    ds_read_b64_tr_b16 a[152:153], v79 offset:192
    ds_read_b64_tr_b16 a[154:155], v79 offset:8896
    s_waitcnt lgkmcnt(14)
    v_mfma_f32_16x16x32_bf16 v[192:195], a[160:163], v[48:51], v[192:195]
    v_add_f32 v74, v74, v59
    v_add_f32 v75, v60, v61
    v_add_f32 v75, v75, v62
    v_mfma_f32_16x16x32_bf16 v[196:199], a[160:163], v[52:55], v[196:199]
    ds_read_b64_tr_b16 a[156:157], v81 offset:224
    ds_read_b64_tr_b16 a[158:159], v81 offset:8928
    v_add_f32 v75, v75, v63
    v_add_f32 v74, v74, v64
    v_add_f32 v74, v74, v65
    v_mfma_f32_16x16x32_bf16 v[200:203], a[164:167], v[48:51], v[200:203]
    v_add_f32 v74, v74, v66
    v_add_f32 v74, v74, v67
    v_add_f32 v75, v75, v68
    v_mfma_f32_16x16x32_bf16 v[204:207], a[164:167], v[52:55], v[204:207]
    v_add_f32 v75, v75, v69
    v_add_f32 v75, v75, v70
    v_add_f32 v75, v75, v71
    v_mfma_f32_16x16x32_bf16 v[208:211], a[168:171], v[48:51], v[208:211]
    v_cvt_pk_bf16_f32 v40, v56, v57
    v_cvt_pk_bf16_f32 v41, v58, v59
    v_cvt_pk_bf16_f32 v44, v60, v61
    v_mfma_f32_16x16x32_bf16 v[212:215], a[168:171], v[52:55], v[212:215]
    ds_read_b64_tr_b16 a[160:161], v79 offset:256
    ds_read_b64_tr_b16 a[162:163], v79 offset:8960
    v_cvt_pk_bf16_f32 v45, v62, v63
    v_cvt_pk_bf16_f32 v42, v64, v65
    v_cvt_pk_bf16_f32 v43, v66, v67
    v_mfma_f32_16x16x32_bf16 v[216:219], a[172:175], v[48:51], v[216:219]
    v_cvt_pk_bf16_f32 v46, v68, v69
    v_cvt_pk_bf16_f32 v47, v70, v71
    v_max_f32 v76, v74, v75
    v_mfma_f32_16x16x32_bf16 v[220:223], a[172:175], v[52:55], v[220:223]
    v_cmp_lt_f32 vcc, s51, v76
    v_mfma_f32_16x16x32_bf16 v[224:227], a[176:179], v[48:51], v[224:227]
    v_mfma_f32_16x16x32_bf16 v[228:231], a[176:179], v[52:55], v[228:231]
    ds_read_b64_tr_b16 a[164:165], v81 offset:288
    ds_read_b64_tr_b16 a[166:167], v81 offset:8992
    v_mfma_f32_16x16x32_bf16 v[232:235], a[180:183], v[48:51], v[232:235]
    v_mfma_f32_16x16x32_bf16 v[236:239], a[180:183], v[52:55], v[236:239]
    v_mfma_f32_16x16x32_bf16 v[240:243], a[184:187], v[48:51], v[240:243]
    v_mfma_f32_16x16x32_bf16 v[244:247], a[184:187], v[52:55], v[244:247]
    ds_read_b64_tr_b16 a[168:169], v79 offset:320
    ds_read_b64_tr_b16 a[170:171], v79 offset:9024
    v_mfma_f32_16x16x32_bf16 v[248:251], a[188:191], v[48:51], v[248:251]
    v_mfma_f32_16x16x32_bf16 v[252:255], a[188:191], v[52:55], v[252:255]
    s_cbranch_vccnz L_raret1
L_backt1:
    v_add_f32 v72, v72, v74
    v_add_f32 v73, v73, v75
    s_branch L_tailB2
L_tailA2:
    ds_read_b64_tr_b16 a[172:173], v81 offset:352
    ds_read_b64_tr_b16 a[174:175], v81 offset:9056
    ds_read_b64_tr_b16 a[176:177], v79 offset:384
    ds_read_b64_tr_b16 a[178:179], v79 offset:9088
    ds_read_b64_tr_b16 a[180:181], v81 offset:416
    ds_read_b64_tr_b16 a[182:183], v81 offset:9120
    ds_read_b64_tr_b16 a[184:185], v79 offset:448
    ds_read_b64_tr_b16 a[186:187], v79 offset:9152
    s_waitcnt lgkmcnt(15)
    v_mfma_f32_16x16x32_bf16 v[128:131], a[128:131], v[40:43], v[128:131]
    s_lshl_b32 s56, s41, 5
    s_sub_u32 s56, s40, s56
    s_add_u32 s56, s56, 32
    v_mfma_f32_16x16x32_bf16 v[132:135], a[128:131], v[44:47], v[132:135]
    ds_read_b64_tr_b16 a[188:189], v81 offset:480
    ds_read_b64_tr_b16 a[190:191], v81 offset:9184
    v_sub_u32 v98, s56, v96
    s_nop 3
    v_cmp_lt_i32_e64 s[64:65], 0, v98
    v_mfma_f32_16x16x32_bf16 v[136:139], a[132:135], v[40:43], v[136:139]
    v_cmp_lt_i32_e64 s[66:67], 1, v98
    v_cmp_lt_i32_e64 s[68:69], 2, v98
    v_cmp_lt_i32_e64 s[70:71], 3, v98
    v_mfma_f32_16x16x32_bf16 v[140:143], a[132:135], v[44:47], v[140:143]
    s_waitcnt vmcnt(8)
    s_barrier
    v_cmp_lt_i32_e64 s[72:73], 16, v98
    v_cmp_lt_i32_e64 s[74:75], 17, v98
    v_cmp_lt_i32_e64 s[76:77], 18, v98
    v_mfma_f32_16x16x32_bf16 v[144:147], a[136:139], v[40:43], v[144:147]
    v_cmp_lt_i32_e64 s[78:79], 19, v98
    s_nop 1
    v_cndmask_b32_e64 v16, v97, v16, s[64:65]
    v_mfma_f32_16x16x32_bf16 v[148:151], a[136:139], v[44:47], v[148:151]
    ds_read_b64_tr_b16 a[128:129], v79 offset:17408
    ds_read_b64_tr_b16 a[130:131], v79 offset:26112
    v_cndmask_b32_e64 v17, v97, v17, s[66:67]
    v_cndmask_b32_e64 v18, v97, v18, s[68:69]
    v_cndmask_b32_e64 v19, v97, v19, s[70:71]
    v_mfma_f32_16x16x32_bf16 v[152:155], a[140:143], v[40:43], v[152:155]
    v_cndmask_b32_e64 v20, v97, v20, s[64:65]
    v_cndmask_b32_e64 v21, v97, v21, s[66:67]
    v_cndmask_b32_e64 v22, v97, v22, s[68:69]
    v_mfma_f32_16x16x32_bf16 v[156:159], a[140:143], v[44:47], v[156:159]
    v_cndmask_b32_e64 v23, v97, v23, s[70:71]
    v_cndmask_b32_e64 v24, v97, v24, s[72:73]
    v_cndmask_b32_e64 v25, v97, v25, s[74:75]
    v_mfma_f32_16x16x32_bf16 v[160:163], a[144:147], v[40:43], v[160:163]
    v_cndmask_b32_e64 v26, v97, v26, s[76:77]
    v_cndmask_b32_e64 v27, v97, v27, s[78:79]
    v_cndmask_b32_e64 v28, v97, v28, s[72:73]
    v_mfma_f32_16x16x32_bf16 v[164:167], a[144:147], v[44:47], v[164:167]
    ds_read_b64_tr_b16 a[132:133], v81 offset:17440
    ds_read_b64_tr_b16 a[134:135], v81 offset:26144
    v_cndmask_b32_e64 v29, v97, v29, s[74:75]
    v_cndmask_b32_e64 v30, v97, v30, s[76:77]
    v_cndmask_b32_e64 v31, v97, v31, s[78:79]
    v_mfma_f32_16x16x32_bf16 v[168:171], a[148:151], v[40:43], v[168:171]
    v_exp_f32 v56, v16
    v_exp_f32 v57, v17
    v_exp_f32 v58, v18
    v_mfma_f32_16x16x32_bf16 v[172:175], a[148:151], v[44:47], v[172:175]
    v_exp_f32 v59, v19
    v_exp_f32 v60, v20
    v_exp_f32 v61, v21
    v_mfma_f32_16x16x32_bf16 v[176:179], a[152:155], v[40:43], v[176:179]
    v_exp_f32 v62, v22
    v_exp_f32 v63, v23
    v_exp_f32 v64, v24
    v_mfma_f32_16x16x32_bf16 v[180:183], a[152:155], v[44:47], v[180:183]
    ds_read_b64_tr_b16 a[136:137], v79 offset:17472
    ds_read_b64_tr_b16 a[138:139], v79 offset:26176
    v_exp_f32 v65, v25
    v_exp_f32 v66, v26
    v_exp_f32 v67, v27
    v_mfma_f32_16x16x32_bf16 v[184:187], a[156:159], v[40:43], v[184:187]
    v_exp_f32 v68, v28
    v_exp_f32 v69, v29
    v_exp_f32 v70, v30
    v_mfma_f32_16x16x32_bf16 v[188:191], a[156:159], v[44:47], v[188:191]
    v_exp_f32 v71, v31
    v_add_f32 v74, v56, v57
    v_add_f32 v74, v74, v58
    ds_read_b64_tr_b16 a[140:141], v81 offset:17504
    ds_read_b64_tr_b16 a[142:143], v81 offset:26208
    ds_read_b64_tr_b16 a[144:145], v79 offset:17536
    ds_read_b64_tr_b16 a[146:147], v79 offset:26240
    ds_read_b64_tr_b16 a[148:149], v81 offset:17568
    ds_read_b64_tr_b16 a[150:151], v81 offset:26272
    ds_read_b64_tr_b16 a[152:153], v79 offset:17600
    ds_read_b64_tr_b16 a[154:155], v79 offset:26304
    s_waitcnt lgkmcnt(14)
    v_mfma_f32_16x16x32_bf16 v[192:195], a[160:163], v[40:43], v[192:195]
    v_add_f32 v74, v74, v59
    v_add_f32 v75, v60, v61
    v_add_f32 v75, v75, v62
    v_mfma_f32_16x16x32_bf16 v[196:199], a[160:163], v[44:47], v[196:199]
    ds_read_b64_tr_b16 a[156:157], v81 offset:17632
    ds_read_b64_tr_b16 a[158:159], v81 offset:26336
    v_add_f32 v75, v75, v63
    v_add_f32 v74, v74, v64
    v_add_f32 v74, v74, v65
    v_mfma_f32_16x16x32_bf16 v[200:203], a[164:167], v[40:43], v[200:203]
    v_add_f32 v74, v74, v66
    v_add_f32 v74, v74, v67
    v_add_f32 v75, v75, v68
    v_mfma_f32_16x16x32_bf16 v[204:207], a[164:167], v[44:47], v[204:207]
    v_add_f32 v75, v75, v69
    v_add_f32 v75, v75, v70
    v_add_f32 v75, v75, v71
    v_mfma_f32_16x16x32_bf16 v[208:211], a[168:171], v[40:43], v[208:211]
    v_cvt_pk_bf16_f32 v48, v56, v57
    v_cvt_pk_bf16_f32 v49, v58, v59
    v_cvt_pk_bf16_f32 v52, v60, v61
    v_mfma_f32_16x16x32_bf16 v[212:215], a[168:171], v[44:47], v[212:215]
    ds_read_b64_tr_b16 a[160:161], v79 offset:17664
    ds_read_b64_tr_b16 a[162:163], v79 offset:26368
    v_cvt_pk_bf16_f32 v53, v62, v63
    v_cvt_pk_bf16_f32 v50, v64, v65
    v_cvt_pk_bf16_f32 v51, v66, v67
    v_mfma_f32_16x16x32_bf16 v[216:219], a[172:175], v[40:43], v[216:219]
    v_cvt_pk_bf16_f32 v54, v68, v69
    v_cvt_pk_bf16_f32 v55, v70, v71
    v_max_f32 v76, v74, v75
    v_mfma_f32_16x16x32_bf16 v[220:223], a[172:175], v[44:47], v[220:223]
    v_cmp_lt_f32 vcc, s51, v76
    v_mfma_f32_16x16x32_bf16 v[224:227], a[176:179], v[40:43], v[224:227]
    v_mfma_f32_16x16x32_bf16 v[228:231], a[176:179], v[44:47], v[228:231]
    ds_read_b64_tr_b16 a[164:165], v81 offset:17696
    ds_read_b64_tr_b16 a[166:167], v81 offset:26400
    v_mfma_f32_16x16x32_bf16 v[232:235], a[180:183], v[40:43], v[232:235]
    v_mfma_f32_16x16x32_bf16 v[236:239], a[180:183], v[44:47], v[236:239]
    v_mfma_f32_16x16x32_bf16 v[240:243], a[184:187], v[40:43], v[240:243]
    v_mfma_f32_16x16x32_bf16 v[244:247], a[184:187], v[44:47], v[244:247]
    ds_read_b64_tr_b16 a[168:169], v79 offset:17728
    ds_read_b64_tr_b16 a[170:171], v79 offset:26432
    v_mfma_f32_16x16x32_bf16 v[248:251], a[188:191], v[40:43], v[248:251]
    v_mfma_f32_16x16x32_bf16 v[252:255], a[188:191], v[44:47], v[252:255]
    s_cbranch_vccnz L_raret2
L_backt2:
    v_add_f32 v72, v72, v74
    v_add_f32 v73, v73, v75
    s_branch L_tailB3
L_tailA3:
    ds_read_b64_tr_b16 a[172:173], v81 offset:17760
    ds_read_b64_tr_b16 a[174:175], v81 offset:26464
    ds_read_b64_tr_b16 a[176:177], v79 offset:17792
    ds_read_b64_tr_b16 a[178:179], v79 offset:26496
    ds_read_b64_tr_b16 a[180:181], v81 offset:17824
    ds_read_b64_tr_b16 a[182:183], v81 offset:26528
    ds_read_b64_tr_b16 a[184:185], v79 offset:17856
    ds_read_b64_tr_b16 a[186:187], v79 offset:26560
    s_waitcnt lgkmcnt(15)
    v_mfma_f32_16x16x32_bf16 v[128:131], a[128:131], v[48:51], v[128:131]
    s_lshl_b32 s56, s41, 5
    s_sub_u32 s56, s40, s56
    s_add_u32 s56, s56, 32
    v_mfma_f32_16x16x32_bf16 v[132:135], a[128:131], v[52:55], v[132:135]
    ds_read_b64_tr_b16 a[188:189], v81 offset:17888
    ds_read_b64_tr_b16 a[190:191], v81 offset:26592
    v_sub_u32 v98, s56, v96
    s_nop 3
    v_cmp_lt_i32_e64 s[64:65], 0, v98
    v_mfma_f32_16x16x32_bf16 v[136:139], a[132:135], v[48:51], v[136:139]
    v_cmp_lt_i32_e64 s[66:67], 1, v98
    v_cmp_lt_i32_e64 s[68:69], 2, v98
    v_cmp_lt_i32_e64 s[70:71], 3, v98
    v_mfma_f32_16x16x32_bf16 v[140:143], a[132:135], v[52:55], v[140:143]
    s_waitcnt vmcnt(8)
    s_barrier
    v_cmp_lt_i32_e64 s[72:73], 16, v98
    v_cmp_lt_i32_e64 s[74:75], 17, v98
    v_cmp_lt_i32_e64 s[76:77], 18, v98
    v_mfma_f32_16x16x32_bf16 v[144:147], a[136:139], v[48:51], v[144:147]
    v_cmp_lt_i32_e64 s[78:79], 19, v98
    s_nop 1
    v_cndmask_b32_e64 v0, v97, v0, s[64:65]
    v_mfma_f32_16x16x32_bf16 v[148:151], a[136:139], v[52:55], v[148:151]
    ds_read_b64_tr_b16 a[128:129], v78 offset:0
    ds_read_b64_tr_b16 a[130:131], v78 offset:8704
    v_cndmask_b32_e64 v1, v97, v1, s[66:67]
    v_cndmask_b32_e64 v2, v97, v2, s[68:69]
    v_cndmask_b32_e64 v3, v97, v3, s[70:71]
    v_mfma_f32_16x16x32_bf16 v[152:155], a[140:143], v[48:51], v[152:155]
    v_cndmask_b32_e64 v4, v97, v4, s[64:65]
    v_cndmask_b32_e64 v5, v97, v5, s[66:67]
    v_cndmask_b32_e64 v6, v97, v6, s[68:69]
    v_mfma_f32_16x16x32_bf16 v[156:159], a[140:143], v[52:55], v[156:159]
    v_cndmask_b32_e64 v7, v97, v7, s[70:71]
    v_cndmask_b32_e64 v8, v97, v8, s[72:73]
    v_cndmask_b32_e64 v9, v97, v9, s[74:75]
    v_mfma_f32_16x16x32_bf16 v[160:163], a[144:147], v[48:51], v[160:163]
    v_cndmask_b32_e64 v10, v97, v10, s[76:77]
    v_cndmask_b32_e64 v11, v97, v11, s[78:79]
    v_cndmask_b32_e64 v12, v97, v12, s[72:73]
    v_mfma_f32_16x16x32_bf16 v[164:167], a[144:147], v[52:55], v[164:167]
    ds_read_b64_tr_b16 a[132:133], v80 offset:32
    ds_read_b64_tr_b16 a[134:135], v80 offset:8736
    v_cndmask_b32_e64 v13, v97, v13, s[74:75]
    v_cndmask_b32_e64 v14, v97, v14, s[76:77]
    v_cndmask_b32_e64 v15, v97, v15, s[78:79]
    v_mfma_f32_16x16x32_bf16 v[168:171], a[148:151], v[48:51], v[168:171]
    v_exp_f32 v56, v0
    v_exp_f32 v57, v1
    v_exp_f32 v58, v2
    v_mfma_f32_16x16x32_bf16 v[172:175], a[148:151], v[52:55], v[172:175]
    v_exp_f32 v59, v3
    v_exp_f32 v60, v4
    v_exp_f32 v61, v5
    v_mfma_f32_16x16x32_bf16 v[176:179], a[152:155], v[48:51], v[176:179]
    v_exp_f32 v62, v6
    v_exp_f32 v63, v7
    v_exp_f32 v64, v8
    v_mfma_f32_16x16x32_bf16 v[180:183], a[152:155], v[52:55], v[180:183]
    ds_read_b64_tr_b16 a[136:137], v78 offset:64
    ds_read_b64_tr_b16 a[138:139], v78 offset:8768
    v_exp_f32 v65, v9
    v_exp_f32 v66, v10
    v_exp_f32 v67, v11
    v_mfma_f32_16x16x32_bf16 v[184:187], a[156:159], v[48:51], v[184:187]
    v_exp_f32 v68, v12
    v_exp_f32 v69, v13
    v_exp_f32 v70, v14
    v_mfma_f32_16x16x32_bf16 v[188:191], a[156:159], v[52:55], v[188:191]
    v_exp_f32 v71, v15
    v_add_f32 v74, v56, v57
    v_add_f32 v74, v74, v58
    ds_read_b64_tr_b16 a[140:141], v80 offset:96
    ds_read_b64_tr_b16 a[142:143], v80 offset:8800
    ds_read_b64_tr_b16 a[144:145], v78 offset:128
    ds_read_b64_tr_b16 a[146:147], v78 offset:8832
    ds_read_b64_tr_b16 a[148:149], v80 offset:160
    ds_read_b64_tr_b16 a[150:151], v80 offset:8864
    ds_read_b64_tr_b16 a[152:153], v78 offset:192
    ds_read_b64_tr_b16 a[154:155], v78 offset:8896
    s_waitcnt lgkmcnt(14)
    v_mfma_f32_16x16x32_bf16 v[192:195], a[160:163], v[48:51], v[192:195]
    v_add_f32 v74, v74, v59
    v_add_f32 v75, v60, v61
    v_add_f32 v75, v75, v62
    v_mfma_f32_16x16x32_bf16 v[196:199], a[160:163], v[52:55], v[196:199]
    ds_read_b64_tr_b16 a[156:157], v80 offset:224
    ds_read_b64_tr_b16 a[158:159], v80 offset:8928
    v_add_f32 v75, v75, v63
    v_add_f32 v74, v74, v64
    v_add_f32 v74, v74, v65
    v_mfma_f32_16x16x32_bf16 v[200:203], a[164:167], v[48:51], v[200:203]
    v_add_f32 v74, v74, v66
    v_add_f32 v74, v74, v67
    v_add_f32 v75, v75, v68
    v_mfma_f32_16x16x32_bf16 v[204:207], a[164:167], v[52:55], v[204:207]
    v_add_f32 v75, v75, v69
    v_add_f32 v75, v75, v70
    v_add_f32 v75, v75, v71
    v_mfma_f32_16x16x32_bf16 v[208:211], a[168:171], v[48:51], v[208:211]
    v_cvt_pk_bf16_f32 v40, v56, v57
    v_cvt_pk_bf16_f32 v41, v58, v59
    v_cvt_pk_bf16_f32 v44, v60, v61
    v_mfma_f32_16x16x32_bf16 v[212:215], a[168:171], v[52:55], v[212:215]
    ds_read_b64_tr_b16 a[160:161], v78 offset:256
    ds_read_b64_tr_b16 a[162:163], v78 offset:8960
    v_cvt_pk_bf16_f32 v45, v62, v63
    v_cvt_pk_bf16_f32 v42, v64, v65
    v_cvt_pk_bf16_f32 v43, v66, v67
    v_mfma_f32_16x16x32_bf16 v[216:219], a[172:175], v[48:51], v[216:219]
    v_cvt_pk_bf16_f32 v46, v68, v69
    v_cvt_pk_bf16_f32 v47, v70, v71
    v_max_f32 v76, v74, v75
    v_mfma_f32_16x16x32_bf16 v[220:223], a[172:175], v[52:55], v[220:223]
    v_cmp_lt_f32 vcc, s51, v76
    v_mfma_f32_16x16x32_bf16 v[224:227], a[176:179], v[48:51], v[224:227]
    v_mfma_f32_16x16x32_bf16 v[228:231], a[176:179], v[52:55], v[228:231]
    ds_read_b64_tr_b16 a[164:165], v80 offset:288
    ds_read_b64_tr_b16 a[166:167], v80 offset:8992
    v_mfma_f32_16x16x32_bf16 v[232:235], a[180:183], v[48:51], v[232:235]
    v_mfma_f32_16x16x32_bf16 v[236:239], a[180:183], v[52:55], v[236:239]
    v_mfma_f32_16x16x32_bf16 v[240:243], a[184:187], v[48:51], v[240:243]
    v_mfma_f32_16x16x32_bf16 v[244:247], a[184:187], v[52:55], v[244:247]
    ds_read_b64_tr_b16 a[168:169], v78 offset:320
    ds_read_b64_tr_b16 a[170:171], v78 offset:9024
    v_mfma_f32_16x16x32_bf16 v[248:251], a[188:191], v[48:51], v[248:251]
    v_mfma_f32_16x16x32_bf16 v[252:255], a[188:191], v[52:55], v[252:255]
    s_cbranch_vccnz L_raret3
L_backt3:
    v_add_f32 v72, v72, v74
    v_add_f32 v73, v73, v75
    s_branch L_tailB0
L_tailB0:
    ds_read_b64_tr_b16 a[172:173], v80 offset:352
    ds_read_b64_tr_b16 a[174:175], v80 offset:9056
    ds_read_b64_tr_b16 a[176:177], v78 offset:384
    ds_read_b64_tr_b16 a[178:179], v78 offset:9088
    ds_read_b64_tr_b16 a[180:181], v80 offset:416
    ds_read_b64_tr_b16 a[182:183], v80 offset:9120
    ds_read_b64_tr_b16 a[184:185], v78 offset:448
    ds_read_b64_tr_b16 a[186:187], v78 offset:9152
    ds_read_b64_tr_b16 a[188:189], v80 offset:480
    ds_read_b64_tr_b16 a[190:191], v80 offset:9184
    s_waitcnt lgkmcnt(15)
    v_mfma_f32_16x16x32_bf16 v[128:131], a[128:131], v[40:43], v[128:131]
    v_mov_b32 v100, v72
    v_mov_b32 v101, v73
    s_nop 1
    v_mfma_f32_16x16x32_bf16 v[132:135], a[128:131], v[44:47], v[132:135]
    v_permlane32_swap_b32 v72, v100
    v_permlane32_swap_b32 v73, v101
    s_nop 1
    v_mfma_f32_16x16x32_bf16 v[136:139], a[132:135], v[40:43], v[136:139]
    v_add_f32 v72, v72, v100
    v_add_f32 v73, v73, v101
    v_mov_b32 v100, v72
    v_mfma_f32_16x16x32_bf16 v[140:143], a[132:135], v[44:47], v[140:143]
    v_mov_b32 v101, v73
    s_nop 1
    v_permlane16_swap_b32 v72, v100
    v_mfma_f32_16x16x32_bf16 v[144:147], a[136:139], v[40:43], v[144:147]
    v_permlane16_swap_b32 v73, v101
    s_nop 1
    v_add_f32 v72, v72, v100
    v_mfma_f32_16x16x32_bf16 v[148:151], a[136:139], v[44:47], v[148:151]
    v_add_f32 v73, v73, v101
    v_rcp_f32 v102, v72
    v_rcp_f32 v103, v73
    v_mfma_f32_16x16x32_bf16 v[152:155], a[140:143], v[40:43], v[152:155]
    s_nop 0
    v_mfma_f32_16x16x32_bf16 v[156:159], a[140:143], v[44:47], v[156:159]
    s_waitcnt lgkmcnt(15)
    v_mfma_f32_16x16x32_bf16 v[160:163], a[144:147], v[40:43], v[160:163]
    v_mul_f32 v128, v128, v102
    v_mul_f32 v129, v129, v102
    v_mul_f32 v130, v130, v102
    v_mul_f32 v131, v131, v102
    v_mul_f32 v136, v136, v102
    v_mul_f32 v137, v137, v102
    v_mul_f32 v138, v138, v102
    v_mul_f32 v139, v139, v102
    v_cvt_pk_bf16_f32 v0, v128, v129
    v_cvt_pk_bf16_f32 v1, v130, v131
    v_cvt_pk_bf16_f32 v2, v136, v137
    v_mfma_f32_16x16x32_bf16 v[164:167], a[144:147], v[44:47], v[164:167]
    v_cvt_pk_bf16_f32 v3, v138, v139
    v_mul_f32 v144, v144, v102
    v_mul_f32 v145, v145, v102
    v_mul_f32 v146, v146, v102
    v_mul_f32 v147, v147, v102
    v_mul_f32 v152, v152, v102
    v_mul_f32 v153, v153, v102
    v_mul_f32 v154, v154, v102
    v_mul_f32 v155, v155, v102
    v_cvt_pk_bf16_f32 v4, v144, v145
    v_cvt_pk_bf16_f32 v5, v146, v147
    v_mfma_f32_16x16x32_bf16 v[168:171], a[148:151], v[40:43], v[168:171]
    v_cvt_pk_bf16_f32 v6, v152, v153
    v_cvt_pk_bf16_f32 v7, v154, v155
    v_permlane16_swap_b32 v0, v2
    v_permlane16_swap_b32 v1, v3
    v_permlane16_swap_b32 v4, v6
    v_permlane16_swap_b32 v5, v7
    v_mov_b32 v8, v0
    v_mov_b32 v9, v1
    v_mov_b32 v10, v2
    v_mov_b32 v11, v3
    v_mov_b32_dpp v0, v4 row_ror:8 row_mask:0xf bank_mask:0xc
    v_mfma_f32_16x16x32_bf16 v[172:175], a[148:151], v[44:47], v[172:175]
    v_mov_b32_dpp v1, v5 row_ror:8 row_mask:0xf bank_mask:0xc
    v_mov_b32_dpp v2, v6 row_ror:8 row_mask:0xf bank_mask:0xc
    v_mov_b32_dpp v3, v7 row_ror:8 row_mask:0xf bank_mask:0xc
    v_mov_b32_dpp v4, v8 row_ror:8 row_mask:0xf bank_mask:0x3
    v_mov_b32_dpp v5, v9 row_ror:8 row_mask:0xf bank_mask:0x3
    v_mov_b32_dpp v6, v10 row_ror:8 row_mask:0xf bank_mask:0x3
    v_mov_b32_dpp v7, v11 row_ror:8 row_mask:0xf bank_mask:0x3
    s_nop 0
    buffer_store_dwordx4 v[0:3], v94, s[32:35], s42 offen sc1
    buffer_store_dwordx4 v[4:7], v94, s[32:35], s62 offen sc1
    v_mul_f32 v132, v132, v103
    v_mfma_f32_16x16x32_bf16 v[176:179], a[152:155], v[40:43], v[176:179]
    v_mul_f32 v133, v133, v103
    v_mul_f32 v134, v134, v103
    v_mul_f32 v135, v135, v103
    v_mul_f32 v140, v140, v103
    v_mul_f32 v141, v141, v103
    v_mul_f32 v142, v142, v103
    v_mul_f32 v143, v143, v103
    v_cvt_pk_bf16_f32 v12, v132, v133
    v_cvt_pk_bf16_f32 v13, v134, v135
    v_cvt_pk_bf16_f32 v14, v140, v141
    v_cvt_pk_bf16_f32 v15, v142, v143
    v_mfma_f32_16x16x32_bf16 v[180:183], a[152:155], v[44:47], v[180:183]
    v_mul_f32 v148, v148, v103
    v_mul_f32 v149, v149, v103
    v_mul_f32 v150, v150, v103
    v_mul_f32 v151, v151, v103
    v_mul_f32 v156, v156, v103
    v_mul_f32 v157, v157, v103
    v_mul_f32 v158, v158, v103
    v_mul_f32 v159, v159, v103
    v_cvt_pk_bf16_f32 v16, v148, v149
    v_cvt_pk_bf16_f32 v17, v150, v151
    v_cvt_pk_bf16_f32 v18, v156, v157
    v_mfma_f32_16x16x32_bf16 v[184:187], a[156:159], v[40:43], v[184:187]
    v_cvt_pk_bf16_f32 v19, v158, v159
    v_permlane16_swap_b32 v12, v14
    v_permlane16_swap_b32 v13, v15
    v_permlane16_swap_b32 v16, v18
    v_permlane16_swap_b32 v17, v19
    v_mov_b32 v20, v12
    v_mov_b32 v21, v13
    v_mov_b32 v22, v14
    v_mov_b32 v23, v15
    v_mov_b32_dpp v12, v16 row_ror:8 row_mask:0xf bank_mask:0xc
    v_mov_b32_dpp v13, v17 row_ror:8 row_mask:0xf bank_mask:0xc
    v_mfma_f32_16x16x32_bf16 v[188:191], a[156:159], v[44:47], v[188:191]
    v_mov_b32_dpp v14, v18 row_ror:8 row_mask:0xf bank_mask:0xc
    v_mov_b32_dpp v15, v19 row_ror:8 row_mask:0xf bank_mask:0xc
    v_mov_b32_dpp v16, v20 row_ror:8 row_mask:0xf bank_mask:0x3
    v_mov_b32_dpp v17, v21 row_ror:8 row_mask:0xf bank_mask:0x3
    v_mov_b32_dpp v18, v22 row_ror:8 row_mask:0xf bank_mask:0x3
    v_mov_b32_dpp v19, v23 row_ror:8 row_mask:0xf bank_mask:0x3
    s_nop 0
    buffer_store_dwordx4 v[12:15], v94, s[32:35], s63 offen sc1
    buffer_store_dwordx4 v[16:19], v94, s[32:35], s88 offen sc1
    s_waitcnt lgkmcnt(8)
    v_mfma_f32_16x16x32_bf16 v[192:195], a[160:163], v[40:43], v[192:195]
    v_mul_f32 v160, v160, v102
    v_mul_f32 v161, v161, v102
    v_mul_f32 v162, v162, v102
    v_mul_f32 v163, v163, v102
    v_mul_f32 v168, v168, v102
    v_mul_f32 v169, v169, v102
    v_mul_f32 v170, v170, v102
    v_mul_f32 v171, v171, v102
    v_cvt_pk_bf16_f32 v24, v160, v161
    v_cvt_pk_bf16_f32 v25, v162, v163
    v_cvt_pk_bf16_f32 v26, v168, v169
    v_mfma_f32_16x16x32_bf16 v[196:199], a[160:163], v[44:47], v[196:199]
    v_cvt_pk_bf16_f32 v27, v170, v171
    v_mul_f32 v176, v176, v102
    v_mul_f32 v177, v177, v102
    v_mul_f32 v178, v178, v102
    v_mul_f32 v179, v179, v102
    v_mul_f32 v184, v184, v102
    v_mul_f32 v185, v185, v102
    v_mul_f32 v186, v186, v102
    v_mul_f32 v187, v187, v102
    v_cvt_pk_bf16_f32 v28, v176, v177
    v_cvt_pk_bf16_f32 v29, v178, v179
    v_mfma_f32_16x16x32_bf16 v[200:203], a[164:167], v[40:43], v[200:203]
    v_cvt_pk_bf16_f32 v30, v184, v185
    v_cvt_pk_bf16_f32 v31, v186, v187
    v_permlane16_swap_b32 v24, v26
    v_permlane16_swap_b32 v25, v27
    v_permlane16_swap_b32 v28, v30
    v_permlane16_swap_b32 v29, v31
    v_mov_b32 v32, v24
    v_mov_b32 v33, v25
    v_mov_b32 v34, v26
    v_mov_b32 v35, v27
    v_mov_b32_dpp v24, v28 row_ror:8 row_mask:0xf bank_mask:0xc
    v_mfma_f32_16x16x32_bf16 v[204:207], a[164:167], v[44:47], v[204:207]
    v_mov_b32_dpp v25, v29 row_ror:8 row_mask:0xf bank_mask:0xc
    v_mov_b32_dpp v26, v30 row_ror:8 row_mask:0xf bank_mask:0xc
    v_mov_b32_dpp v27, v31 row_ror:8 row_mask:0xf bank_mask:0xc
    v_mov_b32_dpp v28, v32 row_ror:8 row_mask:0xf bank_mask:0x3
    v_mov_b32_dpp v29, v33 row_ror:8 row_mask:0xf bank_mask:0x3
    v_mov_b32_dpp v30, v34 row_ror:8 row_mask:0xf bank_mask:0x3
    v_mov_b32_dpp v31, v35 row_ror:8 row_mask:0xf bank_mask:0x3
    s_nop 0
    buffer_store_dwordx4 v[24:27], v94, s[32:35], s42 offen offset:128 sc1
    buffer_store_dwordx4 v[28:31], v94, s[32:35], s62 offen offset:128 sc1
    v_mul_f32 v164, v164, v103
    v_mfma_f32_16x16x32_bf16 v[208:211], a[168:171], v[40:43], v[208:211]
    v_mul_f32 v165, v165, v103
    v_mul_f32 v166, v166, v103
    v_mul_f32 v167, v167, v103
    v_mul_f32 v172, v172, v103
    v_mul_f32 v173, v173, v103
    v_mul_f32 v174, v174, v103
    v_mul_f32 v175, v175, v103
    v_cvt_pk_bf16_f32 v0, v164, v165
    v_cvt_pk_bf16_f32 v1, v166, v167
    v_cvt_pk_bf16_f32 v2, v172, v173
    v_cvt_pk_bf16_f32 v3, v174, v175
    v_mfma_f32_16x16x32_bf16 v[212:215], a[168:171], v[44:47], v[212:215]
    v_mul_f32 v180, v180, v103
    v_mul_f32 v181, v181, v103
    v_mul_f32 v182, v182, v103
    v_mul_f32 v183, v183, v103
    v_mul_f32 v188, v188, v103
    v_mul_f32 v189, v189, v103
    v_mul_f32 v190, v190, v103
    v_mul_f32 v191, v191, v103
    v_cvt_pk_bf16_f32 v4, v180, v181
    v_cvt_pk_bf16_f32 v5, v182, v183
    v_cvt_pk_bf16_f32 v6, v188, v189
    v_mfma_f32_16x16x32_bf16 v[216:219], a[172:175], v[40:43], v[216:219]
    v_cvt_pk_bf16_f32 v7, v190, v191
    v_permlane16_swap_b32 v0, v2
    v_permlane16_swap_b32 v1, v3
    v_permlane16_swap_b32 v4, v6
    v_permlane16_swap_b32 v5, v7
    v_mov_b32 v8, v0
    v_mov_b32 v9, v1
    v_mov_b32 v10, v2
    v_mov_b32 v11, v3
    v_mov_b32_dpp v0, v4 row_ror:8 row_mask:0xf bank_mask:0xc
    v_mov_b32_dpp v1, v5 row_ror:8 row_mask:0xf bank_mask:0xc
    v_mfma_f32_16x16x32_bf16 v[220:223], a[172:175], v[44:47], v[220:223]
    v_mov_b32_dpp v2, v6 row_ror:8 row_mask:0xf bank_mask:0xc
    v_mov_b32_dpp v3, v7 row_ror:8 row_mask:0xf bank_mask:0xc
    v_mov_b32_dpp v4, v8 row_ror:8 row_mask:0xf bank_mask:0x3
    v_mov_b32_dpp v5, v9 row_ror:8 row_mask:0xf bank_mask:0x3
    v_mov_b32_dpp v6, v10 row_ror:8 row_mask:0xf bank_mask:0x3
    v_mov_b32_dpp v7, v11 row_ror:8 row_mask:0xf bank_mask:0x3
    s_nop 0
    buffer_store_dwordx4 v[0:3], v94, s[32:35], s63 offen offset:128 sc1
    buffer_store_dwordx4 v[4:7], v94, s[32:35], s88 offen offset:128 sc1
    s_waitcnt lgkmcnt(0)
    v_mfma_f32_16x16x32_bf16 v[224:227], a[176:179], v[40:43], v[224:227]
    v_mul_f32 v192, v192, v102
    v_mul_f32 v193, v193, v102
    v_mul_f32 v194, v194, v102
    v_mul_f32 v195, v195, v102
    v_mul_f32 v200, v200, v102
    v_mul_f32 v201, v201, v102
    v_mul_f32 v202, v202, v102
    v_mul_f32 v203, v203, v102
    v_cvt_pk_bf16_f32 v12, v192, v193
    v_cvt_pk_bf16_f32 v13, v194, v195
    v_cvt_pk_bf16_f32 v14, v200, v201
    v_mfma_f32_16x16x32_bf16 v[228:231], a[176:179], v[44:47], v[228:231]
    v_cvt_pk_bf16_f32 v15, v202, v203
    v_mul_f32 v208, v208, v102
    v_mul_f32 v209, v209, v102
    v_mul_f32 v210, v210, v102
    v_mul_f32 v211, v211, v102
    v_mul_f32 v216, v216, v102
    v_mul_f32 v217, v217, v102
    v_mul_f32 v218, v218, v102
    v_mul_f32 v219, v219, v102
    v_cvt_pk_bf16_f32 v16, v208, v209
    v_cvt_pk_bf16_f32 v17, v210, v211
    v_mfma_f32_16x16x32_bf16 v[232:235], a[180:183], v[40:43], v[232:235]
    v_cvt_pk_bf16_f32 v18, v216, v217
    v_cvt_pk_bf16_f32 v19, v218, v219
    v_permlane16_swap_b32 v12, v14
    v_permlane16_swap_b32 v13, v15
    v_permlane16_swap_b32 v16, v18
    v_permlane16_swap_b32 v17, v19
    v_mov_b32 v20, v12
    v_mov_b32 v21, v13
    v_mov_b32 v22, v14
    v_mov_b32 v23, v15
    v_mov_b32_dpp v12, v16 row_ror:8 row_mask:0xf bank_mask:0xc
    v_mfma_f32_16x16x32_bf16 v[236:239], a[180:183], v[44:47], v[236:239]
    v_mov_b32_dpp v13, v17 row_ror:8 row_mask:0xf bank_mask:0xc
    v_mov_b32_dpp v14, v18 row_ror:8 row_mask:0xf bank_mask:0xc
    v_mov_b32_dpp v15, v19 row_ror:8 row_mask:0xf bank_mask:0xc
    v_mov_b32_dpp v16, v20 row_ror:8 row_mask:0xf bank_mask:0x3
    v_mov_b32_dpp v17, v21 row_ror:8 row_mask:0xf bank_mask:0x3
    v_mov_b32_dpp v18, v22 row_ror:8 row_mask:0xf bank_mask:0x3
    v_mov_b32_dpp v19, v23 row_ror:8 row_mask:0xf bank_mask:0x3
    s_nop 0
    buffer_store_dwordx4 v[12:15], v94, s[32:35], s42 offen offset:256 sc1
    buffer_store_dwordx4 v[16:19], v94, s[32:35], s62 offen offset:256 sc1
    v_mul_f32 v196, v196, v103
    v_mfma_f32_16x16x32_bf16 v[240:243], a[184:187], v[40:43], v[240:243]
    v_mul_f32 v197, v197, v103
    v_mul_f32 v198, v198, v103
    v_mul_f32 v199, v199, v103
    v_mul_f32 v204, v204, v103
    v_mul_f32 v205, v205, v103
    v_mul_f32 v206, v206, v103
    v_mul_f32 v207, v207, v103
    v_cvt_pk_bf16_f32 v24, v196, v197
    v_cvt_pk_bf16_f32 v25, v198, v199
    v_cvt_pk_bf16_f32 v26, v204, v205
    v_cvt_pk_bf16_f32 v27, v206, v207
    v_mfma_f32_16x16x32_bf16 v[244:247], a[184:187], v[44:47], v[244:247]
    v_mul_f32 v212, v212, v103
    v_mul_f32 v213, v213, v103
    v_mul_f32 v214, v214, v103
    v_mul_f32 v215, v215, v103
    v_mul_f32 v220, v220, v103
    v_mul_f32 v221, v221, v103
    v_mul_f32 v222, v222, v103
    v_mul_f32 v223, v223, v103
    v_cvt_pk_bf16_f32 v28, v212, v213
    v_cvt_pk_bf16_f32 v29, v214, v215
    v_cvt_pk_bf16_f32 v30, v220, v221
    v_mfma_f32_16x16x32_bf16 v[248:251], a[188:191], v[40:43], v[248:251]
    v_cvt_pk_bf16_f32 v31, v222, v223
    v_permlane16_swap_b32 v24, v26
    v_permlane16_swap_b32 v25, v27
    v_permlane16_swap_b32 v28, v30
    v_permlane16_swap_b32 v29, v31
    v_mov_b32 v32, v24
    v_mov_b32 v33, v25
    v_mov_b32 v34, v26
    v_mov_b32 v35, v27
    v_mov_b32_dpp v24, v28 row_ror:8 row_mask:0xf bank_mask:0xc
    v_mov_b32_dpp v25, v29 row_ror:8 row_mask:0xf bank_mask:0xc
    v_mfma_f32_16x16x32_bf16 v[252:255], a[188:191], v[44:47], v[252:255]
    v_mov_b32_dpp v26, v30 row_ror:8 row_mask:0xf bank_mask:0xc
    v_mov_b32_dpp v27, v31 row_ror:8 row_mask:0xf bank_mask:0xc
    v_mov_b32_dpp v28, v32 row_ror:8 row_mask:0xf bank_mask:0x3
    v_mov_b32_dpp v29, v33 row_ror:8 row_mask:0xf bank_mask:0x3
    v_mov_b32_dpp v30, v34 row_ror:8 row_mask:0xf bank_mask:0x3
    v_mov_b32_dpp v31, v35 row_ror:8 row_mask:0xf bank_mask:0x3
    s_nop 0
    buffer_store_dwordx4 v[24:27], v94, s[32:35], s63 offen offset:256 sc1
    buffer_store_dwordx4 v[28:31], v94, s[32:35], s88 offen offset:256 sc1
    s_nop 3
    v_mul_f32 v224, v224, v102
    v_mul_f32 v225, v225, v102
    v_mul_f32 v226, v226, v102
    v_mul_f32 v227, v227, v102
    v_mul_f32 v232, v232, v102
    v_mul_f32 v233, v233, v102
    v_mul_f32 v234, v234, v102
    v_mul_f32 v235, v235, v102
    v_cvt_pk_bf16_f32 v0, v224, v225
    v_cvt_pk_bf16_f32 v1, v226, v227
    v_cvt_pk_bf16_f32 v2, v232, v233
    v_cvt_pk_bf16_f32 v3, v234, v235
    v_mul_f32 v240, v240, v102
    v_mul_f32 v241, v241, v102
    v_mul_f32 v242, v242, v102
    v_mul_f32 v243, v243, v102
    v_mul_f32 v248, v248, v102
    v_mul_f32 v249, v249, v102
    v_mul_f32 v250, v250, v102
    v_mul_f32 v251, v251, v102
    v_cvt_pk_bf16_f32 v4, v240, v241
    v_cvt_pk_bf16_f32 v5, v242, v243
    v_cvt_pk_bf16_f32 v6, v248, v249
    v_cvt_pk_bf16_f32 v7, v250, v251
    v_permlane16_swap_b32 v0, v2
    v_permlane16_swap_b32 v1, v3
    v_permlane16_swap_b32 v4, v6
    v_permlane16_swap_b32 v5, v7
    v_mov_b32 v8, v0
    v_mov_b32 v9, v1
    v_mov_b32 v10, v2
    v_mov_b32 v11, v3
    v_mov_b32_dpp v0, v4 row_ror:8 row_mask:0xf bank_mask:0xc
    v_mov_b32_dpp v1, v5 row_ror:8 row_mask:0xf bank_mask:0xc
    v_mov_b32_dpp v2, v6 row_ror:8 row_mask:0xf bank_mask:0xc
    v_mov_b32_dpp v3, v7 row_ror:8 row_mask:0xf bank_mask:0xc
    v_mov_b32_dpp v4, v8 row_ror:8 row_mask:0xf bank_mask:0x3
    v_mov_b32_dpp v5, v9 row_ror:8 row_mask:0xf bank_mask:0x3
    v_mov_b32_dpp v6, v10 row_ror:8 row_mask:0xf bank_mask:0x3
    v_mov_b32_dpp v7, v11 row_ror:8 row_mask:0xf bank_mask:0x3
    s_nop 0
    buffer_store_dwordx4 v[0:3], v94, s[32:35], s42 offen offset:384 sc1
    buffer_store_dwordx4 v[4:7], v94, s[32:35], s62 offen offset:384 sc1
    v_mul_f32 v228, v228, v103
    v_mul_f32 v229, v229, v103
    v_mul_f32 v230, v230, v103
    v_mul_f32 v231, v231, v103
    v_mul_f32 v236, v236, v103
    v_mul_f32 v237, v237, v103
    v_mul_f32 v238, v238, v103
    v_mul_f32 v239, v239, v103
    v_cvt_pk_bf16_f32 v12, v228, v229
    v_cvt_pk_bf16_f32 v13, v230, v231
    v_cvt_pk_bf16_f32 v14, v236, v237
    v_cvt_pk_bf16_f32 v15, v238, v239
    v_mul_f32 v244, v244, v103
    v_mul_f32 v245, v245, v103
    v_mul_f32 v246, v246, v103
    v_mul_f32 v247, v247, v103
    v_mul_f32 v252, v252, v103
    v_mul_f32 v253, v253, v103
    v_mul_f32 v254, v254, v103
    v_mul_f32 v255, v255, v103
    v_cvt_pk_bf16_f32 v16, v244, v245
    v_cvt_pk_bf16_f32 v17, v246, v247
    v_cvt_pk_bf16_f32 v18, v252, v253
    v_cvt_pk_bf16_f32 v19, v254, v255
    v_permlane16_swap_b32 v12, v14
    v_permlane16_swap_b32 v13, v15
    v_permlane16_swap_b32 v16, v18
    v_permlane16_swap_b32 v17, v19
    v_mov_b32 v20, v12
    v_mov_b32 v21, v13
    v_mov_b32 v22, v14
    v_mov_b32 v23, v15
    v_mov_b32_dpp v12, v16 row_ror:8 row_mask:0xf bank_mask:0xc
    v_mov_b32_dpp v13, v17 row_ror:8 row_mask:0xf bank_mask:0xc
    v_mov_b32_dpp v14, v18 row_ror:8 row_mask:0xf bank_mask:0xc
    v_mov_b32_dpp v15, v19 row_ror:8 row_mask:0xf bank_mask:0xc
    v_mov_b32_dpp v16, v20 row_ror:8 row_mask:0xf bank_mask:0x3
    v_mov_b32_dpp v17, v21 row_ror:8 row_mask:0xf bank_mask:0x3
    v_mov_b32_dpp v18, v22 row_ror:8 row_mask:0xf bank_mask:0x3
    v_mov_b32_dpp v19, v23 row_ror:8 row_mask:0xf bank_mask:0x3
    s_nop 0
    buffer_store_dwordx4 v[12:15], v94, s[32:35], s63 offen offset:384 sc1
    buffer_store_dwordx4 v[16:19], v94, s[32:35], s88 offen offset:384 sc1
    s_branch L_epi
L_tailB1:
    ds_read_b64_tr_b16 a[172:173], v80 offset:17760
    ds_read_b64_tr_b16 a[174:175], v80 offset:26464
    ds_read_b64_tr_b16 a[176:177], v78 offset:17792
    ds_read_b64_tr_b16 a[178:179], v78 offset:26496
    ds_read_b64_tr_b16 a[180:181], v80 offset:17824
    ds_read_b64_tr_b16 a[182:183], v80 offset:26528
    ds_read_b64_tr_b16 a[184:185], v78 offset:17856
    ds_read_b64_tr_b16 a[186:187], v78 offset:26560
    ds_read_b64_tr_b16 a[188:189], v80 offset:17888
    ds_read_b64_tr_b16 a[190:191], v80 offset:26592
    s_waitcnt lgkmcnt(15)
    v_mfma_f32_16x16x32_bf16 v[128:131], a[128:131], v[48:51], v[128:131]
    v_mov_b32 v100, v72
    v_mov_b32 v101, v73
    s_nop 1
    v_mfma_f32_16x16x32_bf16 v[132:135], a[128:131], v[52:55], v[132:135]
    v_permlane32_swap_b32 v72, v100
    v_permlane32_swap_b32 v73, v101
    s_nop 1
    v_mfma_f32_16x16x32_bf16 v[136:139], a[132:135], v[48:51], v[136:139]
    v_add_f32 v72, v72, v100
    v_add_f32 v73, v73, v101
    v_mov_b32 v100, v72
    v_mfma_f32_16x16x32_bf16 v[140:143], a[132:135], v[52:55], v[140:143]
    v_mov_b32 v101, v73
    s_nop 1
    v_permlane16_swap_b32 v72, v100
    v_mfma_f32_16x16x32_bf16 v[144:147], a[136:139], v[48:51], v[144:147]
    v_permlane16_swap_b32 v73, v101
    s_nop 1
    v_add_f32 v72, v72, v100
    v_mfma_f32_16x16x32_bf16 v[148:151], a[136:139], v[52:55], v[148:151]
    v_add_f32 v73, v73, v101
    v_rcp_f32 v102, v72
    v_rcp_f32 v103, v73
    v_mfma_f32_16x16x32_bf16 v[152:155], a[140:143], v[48:51], v[152:155]
    s_nop 0
    v_mfma_f32_16x16x32_bf16 v[156:159], a[140:143], v[52:55], v[156:159]
    s_waitcnt lgkmcnt(15)
    v_mfma_f32_16x16x32_bf16 v[160:163], a[144:147], v[48:51], v[160:163]
    v_mul_f32 v128, v128, v102
    v_mul_f32 v129, v129, v102
    v_mul_f32 v130, v130, v102
    v_mul_f32 v131, v131, v102
    v_mul_f32 v136, v136, v102
    v_mul_f32 v137, v137, v102
    v_mul_f32 v138, v138, v102
    v_mul_f32 v139, v139, v102
    v_cvt_pk_bf16_f32 v0, v128, v129
    v_cvt_pk_bf16_f32 v1, v130, v131
    v_cvt_pk_bf16_f32 v2, v136, v137
    v_mfma_f32_16x16x32_bf16 v[164:167], a[144:147], v[52:55], v[164:167]
    v_cvt_pk_bf16_f32 v3, v138, v139
    v_mul_f32 v144, v144, v102
    v_mul_f32 v145, v145, v102
    v_mul_f32 v146, v146, v102
    v_mul_f32 v147, v147, v102
    v_mul_f32 v152, v152, v102
    v_mul_f32 v153, v153, v102
    v_mul_f32 v154, v154, v102
    v_mul_f32 v155, v155, v102
    v_cvt_pk_bf16_f32 v4, v144, v145
    v_cvt_pk_bf16_f32 v5, v146, v147
    v_mfma_f32_16x16x32_bf16 v[168:171], a[148:151], v[48:51], v[168:171]
    v_cvt_pk_bf16_f32 v6, v152, v153
    v_cvt_pk_bf16_f32 v7, v154, v155
    v_permlane16_swap_b32 v0, v2
    v_permlane16_swap_b32 v1, v3
    v_permlane16_swap_b32 v4, v6
    v_permlane16_swap_b32 v5, v7
    v_mov_b32 v8, v0
    v_mov_b32 v9, v1
    v_mov_b32 v10, v2
    v_mov_b32 v11, v3
    v_mov_b32_dpp v0, v4 row_ror:8 row_mask:0xf bank_mask:0xc
    v_mfma_f32_16x16x32_bf16 v[172:175], a[148:151], v[52:55], v[172:175]
    v_mov_b32_dpp v1, v5 row_ror:8 row_mask:0xf bank_mask:0xc
    v_mov_b32_dpp v2, v6 row_ror:8 row_mask:0xf bank_mask:0xc
    v_mov_b32_dpp v3, v7 row_ror:8 row_mask:0xf bank_mask:0xc
    v_mov_b32_dpp v4, v8 row_ror:8 row_mask:0xf bank_mask:0x3
    v_mov_b32_dpp v5, v9 row_ror:8 row_mask:0xf bank_mask:0x3
    v_mov_b32_dpp v6, v10 row_ror:8 row_mask:0xf bank_mask:0x3
    v_mov_b32_dpp v7, v11 row_ror:8 row_mask:0xf bank_mask:0x3
    s_nop 0
    buffer_store_dwordx4 v[0:3], v94, s[32:35], s42 offen sc1
    buffer_store_dwordx4 v[4:7], v94, s[32:35], s62 offen sc1
    v_mul_f32 v132, v132, v103
    v_mfma_f32_16x16x32_bf16 v[176:179], a[152:155], v[48:51], v[176:179]
    v_mul_f32 v133, v133, v103
    v_mul_f32 v134, v134, v103
    v_mul_f32 v135, v135, v103
    v_mul_f32 v140, v140, v103
    v_mul_f32 v141, v141, v103
    v_mul_f32 v142, v142, v103
    v_mul_f32 v143, v143, v103
    v_cvt_pk_bf16_f32 v12, v132, v133
    v_cvt_pk_bf16_f32 v13, v134, v135
    v_cvt_pk_bf16_f32 v14, v140, v141
    v_cvt_pk_bf16_f32 v15, v142, v143
    v_mfma_f32_16x16x32_bf16 v[180:183], a[152:155], v[52:55], v[180:183]
    v_mul_f32 v148, v148, v103
    v_mul_f32 v149, v149, v103
    v_mul_f32 v150, v150, v103
    v_mul_f32 v151, v151, v103
    v_mul_f32 v156, v156, v103
    v_mul_f32 v157, v157, v103
    v_mul_f32 v158, v158, v103
    v_mul_f32 v159, v159, v103
    v_cvt_pk_bf16_f32 v16, v148, v149
    v_cvt_pk_bf16_f32 v17, v150, v151
    v_cvt_pk_bf16_f32 v18, v156, v157
    v_mfma_f32_16x16x32_bf16 v[184:187], a[156:159], v[48:51], v[184:187]
    v_cvt_pk_bf16_f32 v19, v158, v159
    v_permlane16_swap_b32 v12, v14
    v_permlane16_swap_b32 v13, v15
    v_permlane16_swap_b32 v16, v18
    v_permlane16_swap_b32 v17, v19
    v_mov_b32 v20, v12
    v_mov_b32 v21, v13
    v_mov_b32 v22, v14
    v_mov_b32 v23, v15
    v_mov_b32_dpp v12, v16 row_ror:8 row_mask:0xf bank_mask:0xc
    v_mov_b32_dpp v13, v17 row_ror:8 row_mask:0xf bank_mask:0xc
    v_mfma_f32_16x16x32_bf16 v[188:191], a[156:159], v[52:55], v[188:191]
    v_mov_b32_dpp v14, v18 row_ror:8 row_mask:0xf bank_mask:0xc
    v_mov_b32_dpp v15, v19 row_ror:8 row_mask:0xf bank_mask:0xc
    v_mov_b32_dpp v16, v20 row_ror:8 row_mask:0xf bank_mask:0x3
    v_mov_b32_dpp v17, v21 row_ror:8 row_mask:0xf bank_mask:0x3
    v_mov_b32_dpp v18, v22 row_ror:8 row_mask:0xf bank_mask:0x3
    v_mov_b32_dpp v19, v23 row_ror:8 row_mask:0xf bank_mask:0x3
    s_nop 0
    buffer_store_dwordx4 v[12:15], v94, s[32:35], s63 offen sc1
    buffer_store_dwordx4 v[16:19], v94, s[32:35], s88 offen sc1
    s_waitcnt lgkmcnt(8)
    v_mfma_f32_16x16x32_bf16 v[192:195], a[160:163], v[48:51], v[192:195]
    v_mul_f32 v160, v160, v102
    v_mul_f32 v161, v161, v102
    v_mul_f32 v162, v162, v102
    v_mul_f32 v163, v163, v102
    v_mul_f32 v168, v168, v102
    v_mul_f32 v169, v169, v102
    v_mul_f32 v170, v170, v102
    v_mul_f32 v171, v171, v102
    v_cvt_pk_bf16_f32 v24, v160, v161
    v_cvt_pk_bf16_f32 v25, v162, v163
    v_cvt_pk_bf16_f32 v26, v168, v169
    v_mfma_f32_16x16x32_bf16 v[196:199], a[160:163], v[52:55], v[196:199]
    v_cvt_pk_bf16_f32 v27, v170, v171
    v_mul_f32 v176, v176, v102
    v_mul_f32 v177, v177, v102
    v_mul_f32 v178, v178, v102
    v_mul_f32 v179, v179, v102
    v_mul_f32 v184, v184, v102
    v_mul_f32 v185, v185, v102
    v_mul_f32 v186, v186, v102
    v_mul_f32 v187, v187, v102
    v_cvt_pk_bf16_f32 v28, v176, v177
    v_cvt_pk_bf16_f32 v29, v178, v179
    v_mfma_f32_16x16x32_bf16 v[200:203], a[164:167], v[48:51], v[200:203]
    v_cvt_pk_bf16_f32 v30, v184, v185
    v_cvt_pk_bf16_f32 v31, v186, v187
    v_permlane16_swap_b32 v24, v26
    v_permlane16_swap_b32 v25, v27
    v_permlane16_swap_b32 v28, v30
    v_permlane16_swap_b32 v29, v31
    v_mov_b32 v32, v24
    v_mov_b32 v33, v25
    v_mov_b32 v34, v26
    v_mov_b32 v35, v27
    v_mov_b32_dpp v24, v28 row_ror:8 row_mask:0xf bank_mask:0xc
    v_mfma_f32_16x16x32_bf16 v[204:207], a[164:167], v[52:55], v[204:207]
    v_mov_b32_dpp v25, v29 row_ror:8 row_mask:0xf bank_mask:0xc
    v_mov_b32_dpp v26, v30 row_ror:8 row_mask:0xf bank_mask:0xc
    v_mov_b32_dpp v27, v31 row_ror:8 row_mask:0xf bank_mask:0xc
    v_mov_b32_dpp v28, v32 row_ror:8 row_mask:0xf bank_mask:0x3
    v_mov_b32_dpp v29, v33 row_ror:8 row_mask:0xf bank_mask:0x3
    v_mov_b32_dpp v30, v34 row_ror:8 row_mask:0xf bank_mask:0x3
    v_mov_b32_dpp v31, v35 row_ror:8 row_mask:0xf bank_mask:0x3
    s_nop 0
    buffer_store_dwordx4 v[24:27], v94, s[32:35], s42 offen offset:128 sc1
    buffer_store_dwordx4 v[28:31], v94, s[32:35], s62 offen offset:128 sc1
    v_mul_f32 v164, v164, v103
    v_mfma_f32_16x16x32_bf16 v[208:211], a[168:171], v[48:51], v[208:211]
    v_mul_f32 v165, v165, v103
    v_mul_f32 v166, v166, v103
    v_mul_f32 v167, v167, v103
    v_mul_f32 v172, v172, v103
    v_mul_f32 v173, v173, v103
    v_mul_f32 v174, v174, v103
    v_mul_f32 v175, v175, v103
    v_cvt_pk_bf16_f32 v0, v164, v165
    v_cvt_pk_bf16_f32 v1, v166, v167
    v_cvt_pk_bf16_f32 v2, v172, v173
    v_cvt_pk_bf16_f32 v3, v174, v175
    v_mfma_f32_16x16x32_bf16 v[212:215], a[168:171], v[52:55], v[212:215]
    v_mul_f32 v180, v180, v103
    v_mul_f32 v181, v181, v103
    v_mul_f32 v182, v182, v103
    v_mul_f32 v183, v183, v103
    v_mul_f32 v188, v188, v103
    v_mul_f32 v189, v189, v103
    v_mul_f32 v190, v190, v103
    v_mul_f32 v191, v191, v103
    v_cvt_pk_bf16_f32 v4, v180, v181
    v_cvt_pk_bf16_f32 v5, v182, v183
    v_cvt_pk_bf16_f32 v6, v188, v189
    v_mfma_f32_16x16x32_bf16 v[216:219], a[172:175], v[48:51], v[216:219]
    v_cvt_pk_bf16_f32 v7, v190, v191
    v_permlane16_swap_b32 v0, v2
    v_permlane16_swap_b32 v1, v3
    v_permlane16_swap_b32 v4, v6
    v_permlane16_swap_b32 v5, v7
    v_mov_b32 v8, v0
    v_mov_b32 v9, v1
    v_mov_b32 v10, v2
    v_mov_b32 v11, v3
    v_mov_b32_dpp v0, v4 row_ror:8 row_mask:0xf bank_mask:0xc
    v_mov_b32_dpp v1, v5 row_ror:8 row_mask:0xf bank_mask:0xc
    v_mfma_f32_16x16x32_bf16 v[220:223], a[172:175], v[52:55], v[220:223]
    v_mov_b32_dpp v2, v6 row_ror:8 row_mask:0xf bank_mask:0xc
    v_mov_b32_dpp v3, v7 row_ror:8 row_mask:0xf bank_mask:0xc
    v_mov_b32_dpp v4, v8 row_ror:8 row_mask:0xf bank_mask:0x3
    v_mov_b32_dpp v5, v9 row_ror:8 row_mask:0xf bank_mask:0x3
    v_mov_b32_dpp v6, v10 row_ror:8 row_mask:0xf bank_mask:0x3
    v_mov_b32_dpp v7, v11 row_ror:8 row_mask:0xf bank_mask:0x3
    s_nop 0
    buffer_store_dwordx4 v[0:3], v94, s[32:35], s63 offen offset:128 sc1
    buffer_store_dwordx4 v[4:7], v94, s[32:35], s88 offen offset:128 sc1
    s_waitcnt lgkmcnt(0)
    v_mfma_f32_16x16x32_bf16 v[224:227], a[176:179], v[48:51], v[224:227]
    v_mul_f32 v192, v192, v102
    v_mul_f32 v193, v193, v102
    v_mul_f32 v194, v194, v102
    v_mul_f32 v195, v195, v102
    v_mul_f32 v200, v200, v102
    v_mul_f32 v201, v201, v102
    v_mul_f32 v202, v202, v102
    v_mul_f32 v203, v203, v102
    v_cvt_pk_bf16_f32 v12, v192, v193
    v_cvt_pk_bf16_f32 v13, v194, v195
    v_cvt_pk_bf16_f32 v14, v200, v201
    v_mfma_f32_16x16x32_bf16 v[228:231], a[176:179], v[52:55], v[228:231]
    v_cvt_pk_bf16_f32 v15, v202, v203
    v_mul_f32 v208, v208, v102
    v_mul_f32 v209, v209, v102
    v_mul_f32 v210, v210, v102
    v_mul_f32 v211, v211, v102
    v_mul_f32 v216, v216, v102
    v_mul_f32 v217, v217, v102
    v_mul_f32 v218, v218, v102
    v_mul_f32 v219, v219, v102
    v_cvt_pk_bf16_f32 v16, v208, v209
    v_cvt_pk_bf16_f32 v17, v210, v211
    v_mfma_f32_16x16x32_bf16 v[232:235], a[180:183], v[48:51], v[232:235]
    v_cvt_pk_bf16_f32 v18, v216, v217
    v_cvt_pk_bf16_f32 v19, v218, v219
    v_permlane16_swap_b32 v12, v14
    v_permlane16_swap_b32 v13, v15
    v_permlane16_swap_b32 v16, v18
    v_permlane16_swap_b32 v17, v19
    v_mov_b32 v20, v12
    v_mov_b32 v21, v13
    v_mov_b32 v22, v14
    v_mov_b32 v23, v15
    v_mov_b32_dpp v12, v16 row_ror:8 row_mask:0xf bank_mask:0xc
    v_mfma_f32_16x16x32_bf16 v[236:239], a[180:183], v[52:55], v[236:239]
    v_mov_b32_dpp v13, v17 row_ror:8 row_mask:0xf bank_mask:0xc
    v_mov_b32_dpp v14, v18 row_ror:8 row_mask:0xf bank_mask:0xc
    v_mov_b32_dpp v15, v19 row_ror:8 row_mask:0xf bank_mask:0xc
    v_mov_b32_dpp v16, v20 row_ror:8 row_mask:0xf bank_mask:0x3
    v_mov_b32_dpp v17, v21 row_ror:8 row_mask:0xf bank_mask:0x3
    v_mov_b32_dpp v18, v22 row_ror:8 row_mask:0xf bank_mask:0x3
    v_mov_b32_dpp v19, v23 row_ror:8 row_mask:0xf bank_mask:0x3
    s_nop 0
    buffer_store_dwordx4 v[12:15], v94, s[32:35], s42 offen offset:256 sc1
    buffer_store_dwordx4 v[16:19], v94, s[32:35], s62 offen offset:256 sc1
    v_mul_f32 v196, v196, v103
    v_mfma_f32_16x16x32_bf16 v[240:243], a[184:187], v[48:51], v[240:243]
    v_mul_f32 v197, v197, v103
    v_mul_f32 v198, v198, v103
    v_mul_f32 v199, v199, v103
    v_mul_f32 v204, v204, v103
    v_mul_f32 v205, v205, v103
    v_mul_f32 v206, v206, v103
    v_mul_f32 v207, v207, v103
    v_cvt_pk_bf16_f32 v24, v196, v197
    v_cvt_pk_bf16_f32 v25, v198, v199
    v_cvt_pk_bf16_f32 v26, v204, v205
    v_cvt_pk_bf16_f32 v27, v206, v207
    v_mfma_f32_16x16x32_bf16 v[244:247], a[184:187], v[52:55], v[244:247]
    v_mul_f32 v212, v212, v103
    v_mul_f32 v213, v213, v103
    v_mul_f32 v214, v214, v103
    v_mul_f32 v215, v215, v103
    v_mul_f32 v220, v220, v103
    v_mul_f32 v221, v221, v103
    v_mul_f32 v222, v222, v103
    v_mul_f32 v223, v223, v103
    v_cvt_pk_bf16_f32 v28, v212, v213
    v_cvt_pk_bf16_f32 v29, v214, v215
    v_cvt_pk_bf16_f32 v30, v220, v221
    v_mfma_f32_16x16x32_bf16 v[248:251], a[188:191], v[48:51], v[248:251]
    v_cvt_pk_bf16_f32 v31, v222, v223
    v_permlane16_swap_b32 v24, v26
    v_permlane16_swap_b32 v25, v27
    v_permlane16_swap_b32 v28, v30
    v_permlane16_swap_b32 v29, v31
    v_mov_b32 v32, v24
    v_mov_b32 v33, v25
    v_mov_b32 v34, v26
    v_mov_b32 v35, v27
    v_mov_b32_dpp v24, v28 row_ror:8 row_mask:0xf bank_mask:0xc
    v_mov_b32_dpp v25, v29 row_ror:8 row_mask:0xf bank_mask:0xc
    v_mfma_f32_16x16x32_bf16 v[252:255], a[188:191], v[52:55], v[252:255]
    v_mov_b32_dpp v26, v30 row_ror:8 row_mask:0xf bank_mask:0xc
    v_mov_b32_dpp v27, v31 row_ror:8 row_mask:0xf bank_mask:0xc
    v_mov_b32_dpp v28, v32 row_ror:8 row_mask:0xf bank_mask:0x3
    v_mov_b32_dpp v29, v33 row_ror:8 row_mask:0xf bank_mask:0x3
    v_mov_b32_dpp v30, v34 row_ror:8 row_mask:0xf bank_mask:0x3
    v_mov_b32_dpp v31, v35 row_ror:8 row_mask:0xf bank_mask:0x3
    s_nop 0
    buffer_store_dwordx4 v[24:27], v94, s[32:35], s63 offen offset:256 sc1
    buffer_store_dwordx4 v[28:31], v94, s[32:35], s88 offen offset:256 sc1
    s_nop 3
    v_mul_f32 v224, v224, v102
    v_mul_f32 v225, v225, v102
    v_mul_f32 v226, v226, v102
    v_mul_f32 v227, v227, v102
    v_mul_f32 v232, v232, v102
    v_mul_f32 v233, v233, v102
    v_mul_f32 v234, v234, v102
    v_mul_f32 v235, v235, v102
    v_cvt_pk_bf16_f32 v0, v224, v225
    v_cvt_pk_bf16_f32 v1, v226, v227
    v_cvt_pk_bf16_f32 v2, v232, v233
    v_cvt_pk_bf16_f32 v3, v234, v235
    v_mul_f32 v240, v240, v102
    v_mul_f32 v241, v241, v102
    v_mul_f32 v242, v242, v102
    v_mul_f32 v243, v243, v102
    v_mul_f32 v248, v248, v102
    v_mul_f32 v249, v249, v102
    v_mul_f32 v250, v250, v102
    v_mul_f32 v251, v251, v102
    v_cvt_pk_bf16_f32 v4, v240, v241
    v_cvt_pk_bf16_f32 v5, v242, v243
    v_cvt_pk_bf16_f32 v6, v248, v249
    v_cvt_pk_bf16_f32 v7, v250, v251
    v_permlane16_swap_b32 v0, v2
    v_permlane16_swap_b32 v1, v3
    v_permlane16_swap_b32 v4, v6
    v_permlane16_swap_b32 v5, v7
    v_mov_b32 v8, v0
    v_mov_b32 v9, v1
    v_mov_b32 v10, v2
    v_mov_b32 v11, v3
    v_mov_b32_dpp v0, v4 row_ror:8 row_mask:0xf bank_mask:0xc
    v_mov_b32_dpp v1, v5 row_ror:8 row_mask:0xf bank_mask:0xc
    v_mov_b32_dpp v2, v6 row_ror:8 row_mask:0xf bank_mask:0xc
    v_mov_b32_dpp v3, v7 row_ror:8 row_mask:0xf bank_mask:0xc
    v_mov_b32_dpp v4, v8 row_ror:8 row_mask:0xf bank_mask:0x3
    v_mov_b32_dpp v5, v9 row_ror:8 row_mask:0xf bank_mask:0x3
    v_mov_b32_dpp v6, v10 row_ror:8 row_mask:0xf bank_mask:0x3
    v_mov_b32_dpp v7, v11 row_ror:8 row_mask:0xf bank_mask:0x3
    s_nop 0
    buffer_store_dwordx4 v[0:3], v94, s[32:35], s42 offen offset:384 sc1
    buffer_store_dwordx4 v[4:7], v94, s[32:35], s62 offen offset:384 sc1
    v_mul_f32 v228, v228, v103
    v_mul_f32 v229, v229, v103
    v_mul_f32 v230, v230, v103
    v_mul_f32 v231, v231, v103
    v_mul_f32 v236, v236, v103
    v_mul_f32 v237, v237, v103
    v_mul_f32 v238, v238, v103
    v_mul_f32 v239, v239, v103
    v_cvt_pk_bf16_f32 v12, v228, v229
    v_cvt_pk_bf16_f32 v13, v230, v231
    v_cvt_pk_bf16_f32 v14, v236, v237
    v_cvt_pk_bf16_f32 v15, v238, v239
    v_mul_f32 v244, v244, v103
    v_mul_f32 v245, v245, v103
    v_mul_f32 v246, v246, v103
    v_mul_f32 v247, v247, v103
    v_mul_f32 v252, v252, v103
    v_mul_f32 v253, v253, v103
    v_mul_f32 v254, v254, v103
    v_mul_f32 v255, v255, v103
    v_cvt_pk_bf16_f32 v16, v244, v245
    v_cvt_pk_bf16_f32 v17, v246, v247
    v_cvt_pk_bf16_f32 v18, v252, v253
    v_cvt_pk_bf16_f32 v19, v254, v255
    v_permlane16_swap_b32 v12, v14
    v_permlane16_swap_b32 v13, v15
    v_permlane16_swap_b32 v16, v18
    v_permlane16_swap_b32 v17, v19
    v_mov_b32 v20, v12
    v_mov_b32 v21, v13
    v_mov_b32 v22, v14
    v_mov_b32 v23, v15
    v_mov_b32_dpp v12, v16 row_ror:8 row_mask:0xf bank_mask:0xc
    v_mov_b32_dpp v13, v17 row_ror:8 row_mask:0xf bank_mask:0xc
    v_mov_b32_dpp v14, v18 row_ror:8 row_mask:0xf bank_mask:0xc
    v_mov_b32_dpp v15, v19 row_ror:8 row_mask:0xf bank_mask:0xc
    v_mov_b32_dpp v16, v20 row_ror:8 row_mask:0xf bank_mask:0x3
    v_mov_b32_dpp v17, v21 row_ror:8 row_mask:0xf bank_mask:0x3
    v_mov_b32_dpp v18, v22 row_ror:8 row_mask:0xf bank_mask:0x3
    v_mov_b32_dpp v19, v23 row_ror:8 row_mask:0xf bank_mask:0x3
    s_nop 0
    buffer_store_dwordx4 v[12:15], v94, s[32:35], s63 offen offset:384 sc1
    buffer_store_dwordx4 v[16:19], v94, s[32:35], s88 offen offset:384 sc1
    s_branch L_epi
L_tailB2:
    ds_read_b64_tr_b16 a[172:173], v81 offset:352
    ds_read_b64_tr_b16 a[174:175], v81 offset:9056
    ds_read_b64_tr_b16 a[176:177], v79 offset:384
    ds_read_b64_tr_b16 a[178:179], v79 offset:9088
    ds_read_b64_tr_b16 a[180:181], v81 offset:416
    ds_read_b64_tr_b16 a[182:183], v81 offset:9120
    ds_read_b64_tr_b16 a[184:185], v79 offset:448
    ds_read_b64_tr_b16 a[186:187], v79 offset:9152
    ds_read_b64_tr_b16 a[188:189], v81 offset:480
    ds_read_b64_tr_b16 a[190:191], v81 offset:9184
    s_waitcnt lgkmcnt(15)
    v_mfma_f32_16x16x32_bf16 v[128:131], a[128:131], v[40:43], v[128:131]
    v_mov_b32 v100, v72
    v_mov_b32 v101, v73
    s_nop 1
    v_mfma_f32_16x16x32_bf16 v[132:135], a[128:131], v[44:47], v[132:135]
    v_permlane32_swap_b32 v72, v100
    v_permlane32_swap_b32 v73, v101
    s_nop 1
    v_mfma_f32_16x16x32_bf16 v[136:139], a[132:135], v[40:43], v[136:139]
    v_add_f32 v72, v72, v100
    v_add_f32 v73, v73, v101
    v_mov_b32 v100, v72
    v_mfma_f32_16x16x32_bf16 v[140:143], a[132:135], v[44:47], v[140:143]
    v_mov_b32 v101, v73
    s_nop 1
    v_permlane16_swap_b32 v72, v100
    v_mfma_f32_16x16x32_bf16 v[144:147], a[136:139], v[40:43], v[144:147]
    v_permlane16_swap_b32 v73, v101
    s_nop 1
    v_add_f32 v72, v72, v100
    v_mfma_f32_16x16x32_bf16 v[148:151], a[136:139], v[44:47], v[148:151]
    v_add_f32 v73, v73, v101
    v_rcp_f32 v102, v72
    v_rcp_f32 v103, v73
    v_mfma_f32_16x16x32_bf16 v[152:155], a[140:143], v[40:43], v[152:155]
    s_nop 0
    v_mfma_f32_16x16x32_bf16 v[156:159], a[140:143], v[44:47], v[156:159]
    s_waitcnt lgkmcnt(15)
    v_mfma_f32_16x16x32_bf16 v[160:163], a[144:147], v[40:43], v[160:163]
    v_mul_f32 v128, v128, v102
    v_mul_f32 v129, v129, v102
    v_mul_f32 v130, v130, v102
    v_mul_f32 v131, v131, v102
    v_mul_f32 v136, v136, v102
    v_mul_f32 v137, v137, v102
    v_mul_f32 v138, v138, v102
    v_mul_f32 v139, v139, v102
    v_cvt_pk_bf16_f32 v0, v128, v129
    v_cvt_pk_bf16_f32 v1, v130, v131
    v_cvt_pk_bf16_f32 v2, v136, v137
    v_mfma_f32_16x16x32_bf16 v[164:167], a[144:147], v[44:47], v[164:167]
    v_cvt_pk_bf16_f32 v3, v138, v139
    v_mul_f32 v144, v144, v102
    v_mul_f32 v145, v145, v102
    v_mul_f32 v146, v146, v102
    v_mul_f32 v147, v147, v102
    v_mul_f32 v152, v152, v102
    v_mul_f32 v153, v153, v102
    v_mul_f32 v154, v154, v102
    v_mul_f32 v155, v155, v102
    v_cvt_pk_bf16_f32 v4, v144, v145
    v_cvt_pk_bf16_f32 v5, v146, v147
    v_mfma_f32_16x16x32_bf16 v[168:171], a[148:151], v[40:43], v[168:171]
    v_cvt_pk_bf16_f32 v6, v152, v153
    v_cvt_pk_bf16_f32 v7, v154, v155
    v_permlane16_swap_b32 v0, v2
    v_permlane16_swap_b32 v1, v3
    v_permlane16_swap_b32 v4, v6
    v_permlane16_swap_b32 v5, v7
    v_mov_b32 v8, v0
    v_mov_b32 v9, v1
    v_mov_b32 v10, v2
    v_mov_b32 v11, v3
    v_mov_b32_dpp v0, v4 row_ror:8 row_mask:0xf bank_mask:0xc
    v_mfma_f32_16x16x32_bf16 v[172:175], a[148:151], v[44:47], v[172:175]
    v_mov_b32_dpp v1, v5 row_ror:8 row_mask:0xf bank_mask:0xc
    v_mov_b32_dpp v2, v6 row_ror:8 row_mask:0xf bank_mask:0xc
    v_mov_b32_dpp v3, v7 row_ror:8 row_mask:0xf bank_mask:0xc
    v_mov_b32_dpp v4, v8 row_ror:8 row_mask:0xf bank_mask:0x3
    v_mov_b32_dpp v5, v9 row_ror:8 row_mask:0xf bank_mask:0x3
    v_mov_b32_dpp v6, v10 row_ror:8 row_mask:0xf bank_mask:0x3
    v_mov_b32_dpp v7, v11 row_ror:8 row_mask:0xf bank_mask:0x3
    s_nop 0
    buffer_store_dwordx4 v[0:3], v94, s[32:35], s42 offen sc1
    buffer_store_dwordx4 v[4:7], v94, s[32:35], s62 offen sc1
    v_mul_f32 v132, v132, v103
    v_mfma_f32_16x16x32_bf16 v[176:179], a[152:155], v[40:43], v[176:179]
    v_mul_f32 v133, v133, v103
    v_mul_f32 v134, v134, v103
    v_mul_f32 v135, v135, v103
    v_mul_f32 v140, v140, v103
    v_mul_f32 v141, v141, v103
    v_mul_f32 v142, v142, v103
    v_mul_f32 v143, v143, v103
    v_cvt_pk_bf16_f32 v12, v132, v133
    v_cvt_pk_bf16_f32 v13, v134, v135
    v_cvt_pk_bf16_f32 v14, v140, v141
    v_cvt_pk_bf16_f32 v15, v142, v143
    v_mfma_f32_16x16x32_bf16 v[180:183], a[152:155], v[44:47], v[180:183]
    v_mul_f32 v148, v148, v103
    v_mul_f32 v149, v149, v103
    v_mul_f32 v150, v150, v103
    v_mul_f32 v151, v151, v103
    v_mul_f32 v156, v156, v103
    v_mul_f32 v157, v157, v103
    v_mul_f32 v158, v158, v103
    v_mul_f32 v159, v159, v103
    v_cvt_pk_bf16_f32 v16, v148, v149
    v_cvt_pk_bf16_f32 v17, v150, v151
    v_cvt_pk_bf16_f32 v18, v156, v157
    v_mfma_f32_16x16x32_bf16 v[184:187], a[156:159], v[40:43], v[184:187]
    v_cvt_pk_bf16_f32 v19, v158, v159
    v_permlane16_swap_b32 v12, v14
    v_permlane16_swap_b32 v13, v15
    v_permlane16_swap_b32 v16, v18
    v_permlane16_swap_b32 v17, v19
    v_mov_b32 v20, v12
    v_mov_b32 v21, v13
    v_mov_b32 v22, v14
    v_mov_b32 v23, v15
    v_mov_b32_dpp v12, v16 row_ror:8 row_mask:0xf bank_mask:0xc
    v_mov_b32_dpp v13, v17 row_ror:8 row_mask:0xf bank_mask:0xc
    v_mfma_f32_16x16x32_bf16 v[188:191], a[156:159], v[44:47], v[188:191]
    v_mov_b32_dpp v14, v18 row_ror:8 row_mask:0xf bank_mask:0xc
    v_mov_b32_dpp v15, v19 row_ror:8 row_mask:0xf bank_mask:0xc
    v_mov_b32_dpp v16, v20 row_ror:8 row_mask:0xf bank_mask:0x3
    v_mov_b32_dpp v17, v21 row_ror:8 row_mask:0xf bank_mask:0x3
    v_mov_b32_dpp v18, v22 row_ror:8 row_mask:0xf bank_mask:0x3
    v_mov_b32_dpp v19, v23 row_ror:8 row_mask:0xf bank_mask:0x3
    s_nop 0
    buffer_store_dwordx4 v[12:15], v94, s[32:35], s63 offen sc1
    buffer_store_dwordx4 v[16:19], v94, s[32:35], s88 offen sc1
    s_waitcnt lgkmcnt(8)
    v_mfma_f32_16x16x32_bf16 v[192:195], a[160:163], v[40:43], v[192:195]
    v_mul_f32 v160, v160, v102
    v_mul_f32 v161, v161, v102
    v_mul_f32 v162, v162, v102
    v_mul_f32 v163, v163, v102
    v_mul_f32 v168, v168, v102
    v_mul_f32 v169, v169, v102
    v_mul_f32 v170, v170, v102
    v_mul_f32 v171, v171, v102
    v_cvt_pk_bf16_f32 v24, v160, v161
    v_cvt_pk_bf16_f32 v25, v162, v163
    v_cvt_pk_bf16_f32 v26, v168, v169
    v_mfma_f32_16x16x32_bf16 v[196:199], a[160:163], v[44:47], v[196:199]
    v_cvt_pk_bf16_f32 v27, v170, v171
    v_mul_f32 v176, v176, v102
    v_mul_f32 v177, v177, v102
    v_mul_f32 v178, v178, v102
    v_mul_f32 v179, v179, v102
    v_mul_f32 v184, v184, v102
    v_mul_f32 v185, v185, v102
    v_mul_f32 v186, v186, v102
    v_mul_f32 v187, v187, v102
    v_cvt_pk_bf16_f32 v28, v176, v177
    v_cvt_pk_bf16_f32 v29, v178, v179
    v_mfma_f32_16x16x32_bf16 v[200:203], a[164:167], v[40:43], v[200:203]
    v_cvt_pk_bf16_f32 v30, v184, v185
    v_cvt_pk_bf16_f32 v31, v186, v187
    v_permlane16_swap_b32 v24, v26
    v_permlane16_swap_b32 v25, v27
    v_permlane16_swap_b32 v28, v30
    v_permlane16_swap_b32 v29, v31
    v_mov_b32 v32, v24
    v_mov_b32 v33, v25
    v_mov_b32 v34, v26
    v_mov_b32 v35, v27
    v_mov_b32_dpp v24, v28 row_ror:8 row_mask:0xf bank_mask:0xc
    v_mfma_f32_16x16x32_bf16 v[204:207], a[164:167], v[44:47], v[204:207]
    v_mov_b32_dpp v25, v29 row_ror:8 row_mask:0xf bank_mask:0xc
    v_mov_b32_dpp v26, v30 row_ror:8 row_mask:0xf bank_mask:0xc
    v_mov_b32_dpp v27, v31 row_ror:8 row_mask:0xf bank_mask:0xc
    v_mov_b32_dpp v28, v32 row_ror:8 row_mask:0xf bank_mask:0x3
    v_mov_b32_dpp v29, v33 row_ror:8 row_mask:0xf bank_mask:0x3
    v_mov_b32_dpp v30, v34 row_ror:8 row_mask:0xf bank_mask:0x3
    v_mov_b32_dpp v31, v35 row_ror:8 row_mask:0xf bank_mask:0x3
    s_nop 0
    buffer_store_dwordx4 v[24:27], v94, s[32:35], s42 offen offset:128 sc1
    buffer_store_dwordx4 v[28:31], v94, s[32:35], s62 offen offset:128 sc1
    v_mul_f32 v164, v164, v103
    v_mfma_f32_16x16x32_bf16 v[208:211], a[168:171], v[40:43], v[208:211]
    v_mul_f32 v165, v165, v103
    v_mul_f32 v166, v166, v103
    v_mul_f32 v167, v167, v103
    v_mul_f32 v172, v172, v103
    v_mul_f32 v173, v173, v103
    v_mul_f32 v174, v174, v103
    v_mul_f32 v175, v175, v103
    v_cvt_pk_bf16_f32 v0, v164, v165
    v_cvt_pk_bf16_f32 v1, v166, v167
    v_cvt_pk_bf16_f32 v2, v172, v173
    v_cvt_pk_bf16_f32 v3, v174, v175
    v_mfma_f32_16x16x32_bf16 v[212:215], a[168:171], v[44:47], v[212:215]
    v_mul_f32 v180, v180, v103
    v_mul_f32 v181, v181, v103
    v_mul_f32 v182, v182, v103
    v_mul_f32 v183, v183, v103
    v_mul_f32 v188, v188, v103
    v_mul_f32 v189, v189, v103
    v_mul_f32 v190, v190, v103
    v_mul_f32 v191, v191, v103
    v_cvt_pk_bf16_f32 v4, v180, v181
    v_cvt_pk_bf16_f32 v5, v182, v183
    v_cvt_pk_bf16_f32 v6, v188, v189
    v_mfma_f32_16x16x32_bf16 v[216:219], a[172:175], v[40:43], v[216:219]
    v_cvt_pk_bf16_f32 v7, v190, v191
    v_permlane16_swap_b32 v0, v2
    v_permlane16_swap_b32 v1, v3
    v_permlane16_swap_b32 v4, v6
    v_permlane16_swap_b32 v5, v7
    v_mov_b32 v8, v0
    v_mov_b32 v9, v1
    v_mov_b32 v10, v2
    v_mov_b32 v11, v3
    v_mov_b32_dpp v0, v4 row_ror:8 row_mask:0xf bank_mask:0xc
    v_mov_b32_dpp v1, v5 row_ror:8 row_mask:0xf bank_mask:0xc
    v_mfma_f32_16x16x32_bf16 v[220:223], a[172:175], v[44:47], v[220:223]
    v_mov_b32_dpp v2, v6 row_ror:8 row_mask:0xf bank_mask:0xc
    v_mov_b32_dpp v3, v7 row_ror:8 row_mask:0xf bank_mask:0xc
    v_mov_b32_dpp v4, v8 row_ror:8 row_mask:0xf bank_mask:0x3
    v_mov_b32_dpp v5, v9 row_ror:8 row_mask:0xf bank_mask:0x3
    v_mov_b32_dpp v6, v10 row_ror:8 row_mask:0xf bank_mask:0x3
    v_mov_b32_dpp v7, v11 row_ror:8 row_mask:0xf bank_mask:0x3
    s_nop 0
    buffer_store_dwordx4 v[0:3], v94, s[32:35], s63 offen offset:128 sc1
    buffer_store_dwordx4 v[4:7], v94, s[32:35], s88 offen offset:128 sc1
    s_waitcnt lgkmcnt(0)
    v_mfma_f32_16x16x32_bf16 v[224:227], a[176:179], v[40:43], v[224:227]
    v_mul_f32 v192, v192, v102
    v_mul_f32 v193, v193, v102
    v_mul_f32 v194, v194, v102
    v_mul_f32 v195, v195, v102
    v_mul_f32 v200, v200, v102
    v_mul_f32 v201, v201, v102
    v_mul_f32 v202, v202, v102
    v_mul_f32 v203, v203, v102
    v_cvt_pk_bf16_f32 v12, v192, v193
    v_cvt_pk_bf16_f32 v13, v194, v195
    v_cvt_pk_bf16_f32 v14, v200, v201
    v_mfma_f32_16x16x32_bf16 v[228:231], a[176:179], v[44:47], v[228:231]
    v_cvt_pk_bf16_f32 v15, v202, v203
    v_mul_f32 v208, v208, v102
    v_mul_f32 v209, v209, v102
    v_mul_f32 v210, v210, v102
    v_mul_f32 v211, v211, v102
    v_mul_f32 v216, v216, v102
    v_mul_f32 v217, v217, v102
    v_mul_f32 v218, v218, v102
    v_mul_f32 v219, v219, v102
    v_cvt_pk_bf16_f32 v16, v208, v209
    v_cvt_pk_bf16_f32 v17, v210, v211
    v_mfma_f32_16x16x32_bf16 v[232:235], a[180:183], v[40:43], v[232:235]
    v_cvt_pk_bf16_f32 v18, v216, v217
    v_cvt_pk_bf16_f32 v19, v218, v219
    v_permlane16_swap_b32 v12, v14
    v_permlane16_swap_b32 v13, v15
    v_permlane16_swap_b32 v16, v18
    v_permlane16_swap_b32 v17, v19
    v_mov_b32 v20, v12
    v_mov_b32 v21, v13
    v_mov_b32 v22, v14
    v_mov_b32 v23, v15
    v_mov_b32_dpp v12, v16 row_ror:8 row_mask:0xf bank_mask:0xc
    v_mfma_f32_16x16x32_bf16 v[236:239], a[180:183], v[44:47], v[236:239]
    v_mov_b32_dpp v13, v17 row_ror:8 row_mask:0xf bank_mask:0xc
    v_mov_b32_dpp v14, v18 row_ror:8 row_mask:0xf bank_mask:0xc
    v_mov_b32_dpp v15, v19 row_ror:8 row_mask:0xf bank_mask:0xc
    v_mov_b32_dpp v16, v20 row_ror:8 row_mask:0xf bank_mask:0x3
    v_mov_b32_dpp v17, v21 row_ror:8 row_mask:0xf bank_mask:0x3
    v_mov_b32_dpp v18, v22 row_ror:8 row_mask:0xf bank_mask:0x3
    v_mov_b32_dpp v19, v23 row_ror:8 row_mask:0xf bank_mask:0x3
    s_nop 0
    buffer_store_dwordx4 v[12:15], v94, s[32:35], s42 offen offset:256 sc1
    buffer_store_dwordx4 v[16:19], v94, s[32:35], s62 offen offset:256 sc1
    v_mul_f32 v196, v196, v103
    v_mfma_f32_16x16x32_bf16 v[240:243], a[184:187], v[40:43], v[240:243]
    v_mul_f32 v197, v197, v103
    v_mul_f32 v198, v198, v103
    v_mul_f32 v199, v199, v103
    v_mul_f32 v204, v204, v103
    v_mul_f32 v205, v205, v103
    v_mul_f32 v206, v206, v103
    v_mul_f32 v207, v207, v103
    v_cvt_pk_bf16_f32 v24, v196, v197
    v_cvt_pk_bf16_f32 v25, v198, v199
    v_cvt_pk_bf16_f32 v26, v204, v205
    v_cvt_pk_bf16_f32 v27, v206, v207
    v_mfma_f32_16x16x32_bf16 v[244:247], a[184:187], v[44:47], v[244:247]
    v_mul_f32 v212, v212, v103
    v_mul_f32 v213, v213, v103
    v_mul_f32 v214, v214, v103
    v_mul_f32 v215, v215, v103
    v_mul_f32 v220, v220, v103
    v_mul_f32 v221, v221, v103
    v_mul_f32 v222, v222, v103
    v_mul_f32 v223, v223, v103
    v_cvt_pk_bf16_f32 v28, v212, v213
    v_cvt_pk_bf16_f32 v29, v214, v215
    v_cvt_pk_bf16_f32 v30, v220, v221
    v_mfma_f32_16x16x32_bf16 v[248:251], a[188:191], v[40:43], v[248:251]
    v_cvt_pk_bf16_f32 v31, v222, v223
    v_permlane16_swap_b32 v24, v26
    v_permlane16_swap_b32 v25, v27
    v_permlane16_swap_b32 v28, v30
    v_permlane16_swap_b32 v29, v31
    v_mov_b32 v32, v24
    v_mov_b32 v33, v25
    v_mov_b32 v34, v26
    v_mov_b32 v35, v27
    v_mov_b32_dpp v24, v28 row_ror:8 row_mask:0xf bank_mask:0xc
    v_mov_b32_dpp v25, v29 row_ror:8 row_mask:0xf bank_mask:0xc
    v_mfma_f32_16x16x32_bf16 v[252:255], a[188:191], v[44:47], v[252:255]
    v_mov_b32_dpp v26, v30 row_ror:8 row_mask:0xf bank_mask:0xc
    v_mov_b32_dpp v27, v31 row_ror:8 row_mask:0xf bank_mask:0xc
    v_mov_b32_dpp v28, v32 row_ror:8 row_mask:0xf bank_mask:0x3
    v_mov_b32_dpp v29, v33 row_ror:8 row_mask:0xf bank_mask:0x3
    v_mov_b32_dpp v30, v34 row_ror:8 row_mask:0xf bank_mask:0x3
    v_mov_b32_dpp v31, v35 row_ror:8 row_mask:0xf bank_mask:0x3
    s_nop 0
    buffer_store_dwordx4 v[24:27], v94, s[32:35], s63 offen offset:256 sc1
    buffer_store_dwordx4 v[28:31], v94, s[32:35], s88 offen offset:256 sc1
    s_nop 3
    v_mul_f32 v224, v224, v102
    v_mul_f32 v225, v225, v102
    v_mul_f32 v226, v226, v102
    v_mul_f32 v227, v227, v102
    v_mul_f32 v232, v232, v102
    v_mul_f32 v233, v233, v102
    v_mul_f32 v234, v234, v102
    v_mul_f32 v235, v235, v102
    v_cvt_pk_bf16_f32 v0, v224, v225
    v_cvt_pk_bf16_f32 v1, v226, v227
    v_cvt_pk_bf16_f32 v2, v232, v233
    v_cvt_pk_bf16_f32 v3, v234, v235
    v_mul_f32 v240, v240, v102
    v_mul_f32 v241, v241, v102
    v_mul_f32 v242, v242, v102
    v_mul_f32 v243, v243, v102
    v_mul_f32 v248, v248, v102
    v_mul_f32 v249, v249, v102
    v_mul_f32 v250, v250, v102
    v_mul_f32 v251, v251, v102
    v_cvt_pk_bf16_f32 v4, v240, v241
    v_cvt_pk_bf16_f32 v5, v242, v243
    v_cvt_pk_bf16_f32 v6, v248, v249
    v_cvt_pk_bf16_f32 v7, v250, v251
    v_permlane16_swap_b32 v0, v2
    v_permlane16_swap_b32 v1, v3
    v_permlane16_swap_b32 v4, v6
    v_permlane16_swap_b32 v5, v7
    v_mov_b32 v8, v0
    v_mov_b32 v9, v1
    v_mov_b32 v10, v2
    v_mov_b32 v11, v3
    v_mov_b32_dpp v0, v4 row_ror:8 row_mask:0xf bank_mask:0xc
    v_mov_b32_dpp v1, v5 row_ror:8 row_mask:0xf bank_mask:0xc
    v_mov_b32_dpp v2, v6 row_ror:8 row_mask:0xf bank_mask:0xc
    v_mov_b32_dpp v3, v7 row_ror:8 row_mask:0xf bank_mask:0xc
    v_mov_b32_dpp v4, v8 row_ror:8 row_mask:0xf bank_mask:0x3
    v_mov_b32_dpp v5, v9 row_ror:8 row_mask:0xf bank_mask:0x3
    v_mov_b32_dpp v6, v10 row_ror:8 row_mask:0xf bank_mask:0x3
    v_mov_b32_dpp v7, v11 row_ror:8 row_mask:0xf bank_mask:0x3
    s_nop 0
    buffer_store_dwordx4 v[0:3], v94, s[32:35], s42 offen offset:384 sc1
    buffer_store_dwordx4 v[4:7], v94, s[32:35], s62 offen offset:384 sc1
    v_mul_f32 v228, v228, v103
    v_mul_f32 v229, v229, v103
    v_mul_f32 v230, v230, v103
    v_mul_f32 v231, v231, v103
    v_mul_f32 v236, v236, v103
    v_mul_f32 v237, v237, v103
    v_mul_f32 v238, v238, v103
    v_mul_f32 v239, v239, v103
    v_cvt_pk_bf16_f32 v12, v228, v229
    v_cvt_pk_bf16_f32 v13, v230, v231
    v_cvt_pk_bf16_f32 v14, v236, v237
    v_cvt_pk_bf16_f32 v15, v238, v239
    v_mul_f32 v244, v244, v103
    v_mul_f32 v245, v245, v103
    v_mul_f32 v246, v246, v103
    v_mul_f32 v247, v247, v103
    v_mul_f32 v252, v252, v103
    v_mul_f32 v253, v253, v103
    v_mul_f32 v254, v254, v103
    v_mul_f32 v255, v255, v103
    v_cvt_pk_bf16_f32 v16, v244, v245
    v_cvt_pk_bf16_f32 v17, v246, v247
    v_cvt_pk_bf16_f32 v18, v252, v253
    v_cvt_pk_bf16_f32 v19, v254, v255
    v_permlane16_swap_b32 v12, v14
    v_permlane16_swap_b32 v13, v15
    v_permlane16_swap_b32 v16, v18
    v_permlane16_swap_b32 v17, v19
    v_mov_b32 v20, v12
    v_mov_b32 v21, v13
    v_mov_b32 v22, v14
    v_mov_b32 v23, v15
    v_mov_b32_dpp v12, v16 row_ror:8 row_mask:0xf bank_mask:0xc
    v_mov_b32_dpp v13, v17 row_ror:8 row_mask:0xf bank_mask:0xc
    v_mov_b32_dpp v14, v18 row_ror:8 row_mask:0xf bank_mask:0xc
    v_mov_b32_dpp v15, v19 row_ror:8 row_mask:0xf bank_mask:0xc
    v_mov_b32_dpp v16, v20 row_ror:8 row_mask:0xf bank_mask:0x3
    v_mov_b32_dpp v17, v21 row_ror:8 row_mask:0xf bank_mask:0x3
    v_mov_b32_dpp v18, v22 row_ror:8 row_mask:0xf bank_mask:0x3
    v_mov_b32_dpp v19, v23 row_ror:8 row_mask:0xf bank_mask:0x3
    s_nop 0
    buffer_store_dwordx4 v[12:15], v94, s[32:35], s63 offen offset:384 sc1
    buffer_store_dwordx4 v[16:19], v94, s[32:35], s88 offen offset:384 sc1
    s_branch L_epi
L_tailB3:
    ds_read_b64_tr_b16 a[172:173], v81 offset:17760
    ds_read_b64_tr_b16 a[174:175], v81 offset:26464
    ds_read_b64_tr_b16 a[176:177], v79 offset:17792
    ds_read_b64_tr_b16 a[178:179], v79 offset:26496
    ds_read_b64_tr_b16 a[180:181], v81 offset:17824
    ds_read_b64_tr_b16 a[182:183], v81 offset:26528
    ds_read_b64_tr_b16 a[184:185], v79 offset:17856
    ds_read_b64_tr_b16 a[186:187], v79 offset:26560
    ds_read_b64_tr_b16 a[188:189], v81 offset:17888
    ds_read_b64_tr_b16 a[190:191], v81 offset:26592
    s_waitcnt lgkmcnt(15)
    v_mfma_f32_16x16x32_bf16 v[128:131], a[128:131], v[48:51], v[128:131]
    v_mov_b32 v100, v72
    v_mov_b32 v101, v73
    s_nop 1
    v_mfma_f32_16x16x32_bf16 v[132:135], a[128:131], v[52:55], v[132:135]
    v_permlane32_swap_b32 v72, v100
    v_permlane32_swap_b32 v73, v101
    s_nop 1
    v_mfma_f32_16x16x32_bf16 v[136:139], a[132:135], v[48:51], v[136:139]
    v_add_f32 v72, v72, v100
    v_add_f32 v73, v73, v101
    v_mov_b32 v100, v72
    v_mfma_f32_16x16x32_bf16 v[140:143], a[132:135], v[52:55], v[140:143]
    v_mov_b32 v101, v73
    s_nop 1
    v_permlane16_swap_b32 v72, v100
    v_mfma_f32_16x16x32_bf16 v[144:147], a[136:139], v[48:51], v[144:147]
    v_permlane16_swap_b32 v73, v101
    s_nop 1
    v_add_f32 v72, v72, v100
    v_mfma_f32_16x16x32_bf16 v[148:151], a[136:139], v[52:55], v[148:151]
    v_add_f32 v73, v73, v101
    v_rcp_f32 v102, v72
    v_rcp_f32 v103, v73
    v_mfma_f32_16x16x32_bf16 v[152:155], a[140:143], v[48:51], v[152:155]
    s_nop 0
    v_mfma_f32_16x16x32_bf16 v[156:159], a[140:143], v[52:55], v[156:159]
    s_waitcnt lgkmcnt(15)
    v_mfma_f32_16x16x32_bf16 v[160:163], a[144:147], v[48:51], v[160:163]
    v_mul_f32 v128, v128, v102
    v_mul_f32 v129, v129, v102
    v_mul_f32 v130, v130, v102
    v_mul_f32 v131, v131, v102
    v_mul_f32 v136, v136, v102
    v_mul_f32 v137, v137, v102
    v_mul_f32 v138, v138, v102
    v_mul_f32 v139, v139, v102
    v_cvt_pk_bf16_f32 v0, v128, v129
    v_cvt_pk_bf16_f32 v1, v130, v131
    v_cvt_pk_bf16_f32 v2, v136, v137
    v_mfma_f32_16x16x32_bf16 v[164:167], a[144:147], v[52:55], v[164:167]
    v_cvt_pk_bf16_f32 v3, v138, v139
    v_mul_f32 v144, v144, v102
    v_mul_f32 v145, v145, v102
    v_mul_f32 v146, v146, v102
    v_mul_f32 v147, v147, v102
    v_mul_f32 v152, v152, v102
    v_mul_f32 v153, v153, v102
    v_mul_f32 v154, v154, v102
    v_mul_f32 v155, v155, v102
    v_cvt_pk_bf16_f32 v4, v144, v145
    v_cvt_pk_bf16_f32 v5, v146, v147
    v_mfma_f32_16x16x32_bf16 v[168:171], a[148:151], v[48:51], v[168:171]
    v_cvt_pk_bf16_f32 v6, v152, v153
    v_cvt_pk_bf16_f32 v7, v154, v155
    v_permlane16_swap_b32 v0, v2
    v_permlane16_swap_b32 v1, v3
    v_permlane16_swap_b32 v4, v6
    v_permlane16_swap_b32 v5, v7
    v_mov_b32 v8, v0
    v_mov_b32 v9, v1
    v_mov_b32 v10, v2
    v_mov_b32 v11, v3
    v_mov_b32_dpp v0, v4 row_ror:8 row_mask:0xf bank_mask:0xc
    v_mfma_f32_16x16x32_bf16 v[172:175], a[148:151], v[52:55], v[172:175]
    v_mov_b32_dpp v1, v5 row_ror:8 row_mask:0xf bank_mask:0xc
    v_mov_b32_dpp v2, v6 row_ror:8 row_mask:0xf bank_mask:0xc
    v_mov_b32_dpp v3, v7 row_ror:8 row_mask:0xf bank_mask:0xc
    v_mov_b32_dpp v4, v8 row_ror:8 row_mask:0xf bank_mask:0x3
    v_mov_b32_dpp v5, v9 row_ror:8 row_mask:0xf bank_mask:0x3
    v_mov_b32_dpp v6, v10 row_ror:8 row_mask:0xf bank_mask:0x3
    v_mov_b32_dpp v7, v11 row_ror:8 row_mask:0xf bank_mask:0x3
    s_nop 0
    buffer_store_dwordx4 v[0:3], v94, s[32:35], s42 offen sc1
    buffer_store_dwordx4 v[4:7], v94, s[32:35], s62 offen sc1
    v_mul_f32 v132, v132, v103
    v_mfma_f32_16x16x32_bf16 v[176:179], a[152:155], v[48:51], v[176:179]
    v_mul_f32 v133, v133, v103
    v_mul_f32 v134, v134, v103
    v_mul_f32 v135, v135, v103
    v_mul_f32 v140, v140, v103
    v_mul_f32 v141, v141, v103
    v_mul_f32 v142, v142, v103
    v_mul_f32 v143, v143, v103
    v_cvt_pk_bf16_f32 v12, v132, v133
    v_cvt_pk_bf16_f32 v13, v134, v135
    v_cvt_pk_bf16_f32 v14, v140, v141
    v_cvt_pk_bf16_f32 v15, v142, v143
    v_mfma_f32_16x16x32_bf16 v[180:183], a[152:155], v[52:55], v[180:183]
    v_mul_f32 v148, v148, v103
    v_mul_f32 v149, v149, v103
    v_mul_f32 v150, v150, v103
    v_mul_f32 v151, v151, v103
    v_mul_f32 v156, v156, v103
    v_mul_f32 v157, v157, v103
    v_mul_f32 v158, v158, v103
    v_mul_f32 v159, v159, v103
    v_cvt_pk_bf16_f32 v16, v148, v149
    v_cvt_pk_bf16_f32 v17, v150, v151
    v_cvt_pk_bf16_f32 v18, v156, v157
    v_mfma_f32_16x16x32_bf16 v[184:187], a[156:159], v[48:51], v[184:187]
    v_cvt_pk_bf16_f32 v19, v158, v159
    v_permlane16_swap_b32 v12, v14
    v_permlane16_swap_b32 v13, v15
    v_permlane16_swap_b32 v16, v18
    v_permlane16_swap_b32 v17, v19
    v_mov_b32 v20, v12
    v_mov_b32 v21, v13
    v_mov_b32 v22, v14
    v_mov_b32 v23, v15
    v_mov_b32_dpp v12, v16 row_ror:8 row_mask:0xf bank_mask:0xc
    v_mov_b32_dpp v13, v17 row_ror:8 row_mask:0xf bank_mask:0xc
    v_mfma_f32_16x16x32_bf16 v[188:191], a[156:159], v[52:55], v[188:191]
    v_mov_b32_dpp v14, v18 row_ror:8 row_mask:0xf bank_mask:0xc
    v_mov_b32_dpp v15, v19 row_ror:8 row_mask:0xf bank_mask:0xc
    v_mov_b32_dpp v16, v20 row_ror:8 row_mask:0xf bank_mask:0x3
    v_mov_b32_dpp v17, v21 row_ror:8 row_mask:0xf bank_mask:0x3
    v_mov_b32_dpp v18, v22 row_ror:8 row_mask:0xf bank_mask:0x3
    v_mov_b32_dpp v19, v23 row_ror:8 row_mask:0xf bank_mask:0x3
    s_nop 0
    buffer_store_dwordx4 v[12:15], v94, s[32:35], s63 offen sc1
    buffer_store_dwordx4 v[16:19], v94, s[32:35], s88 offen sc1
    s_waitcnt lgkmcnt(8)
    v_mfma_f32_16x16x32_bf16 v[192:195], a[160:163], v[48:51], v[192:195]
    v_mul_f32 v160, v160, v102
    v_mul_f32 v161, v161, v102
    v_mul_f32 v162, v162, v102
    v_mul_f32 v163, v163, v102
    v_mul_f32 v168, v168, v102
    v_mul_f32 v169, v169, v102
    v_mul_f32 v170, v170, v102
    v_mul_f32 v171, v171, v102
    v_cvt_pk_bf16_f32 v24, v160, v161
    v_cvt_pk_bf16_f32 v25, v162, v163
    v_cvt_pk_bf16_f32 v26, v168, v169
    v_mfma_f32_16x16x32_bf16 v[196:199], a[160:163], v[52:55], v[196:199]
    v_cvt_pk_bf16_f32 v27, v170, v171
    v_mul_f32 v176, v176, v102
    v_mul_f32 v177, v177, v102
    v_mul_f32 v178, v178, v102
    v_mul_f32 v179, v179, v102
    v_mul_f32 v184, v184, v102
    v_mul_f32 v185, v185, v102
    v_mul_f32 v186, v186, v102
    v_mul_f32 v187, v187, v102
    v_cvt_pk_bf16_f32 v28, v176, v177
    v_cvt_pk_bf16_f32 v29, v178, v179
    v_mfma_f32_16x16x32_bf16 v[200:203], a[164:167], v[48:51], v[200:203]
    v_cvt_pk_bf16_f32 v30, v184, v185
    v_cvt_pk_bf16_f32 v31, v186, v187
    v_permlane16_swap_b32 v24, v26
    v_permlane16_swap_b32 v25, v27
    v_permlane16_swap_b32 v28, v30
    v_permlane16_swap_b32 v29, v31
    v_mov_b32 v32, v24
    v_mov_b32 v33, v25
    v_mov_b32 v34, v26
    v_mov_b32 v35, v27
    v_mov_b32_dpp v24, v28 row_ror:8 row_mask:0xf bank_mask:0xc
    v_mfma_f32_16x16x32_bf16 v[204:207], a[164:167], v[52:55], v[204:207]
    v_mov_b32_dpp v25, v29 row_ror:8 row_mask:0xf bank_mask:0xc
    v_mov_b32_dpp v26, v30 row_ror:8 row_mask:0xf bank_mask:0xc
    v_mov_b32_dpp v27, v31 row_ror:8 row_mask:0xf bank_mask:0xc
    v_mov_b32_dpp v28, v32 row_ror:8 row_mask:0xf bank_mask:0x3
    v_mov_b32_dpp v29, v33 row_ror:8 row_mask:0xf bank_mask:0x3
    v_mov_b32_dpp v30, v34 row_ror:8 row_mask:0xf bank_mask:0x3
    v_mov_b32_dpp v31, v35 row_ror:8 row_mask:0xf bank_mask:0x3
    s_nop 0
    buffer_store_dwordx4 v[24:27], v94, s[32:35], s42 offen offset:128 sc1
    buffer_store_dwordx4 v[28:31], v94, s[32:35], s62 offen offset:128 sc1
    v_mul_f32 v164, v164, v103
    v_mfma_f32_16x16x32_bf16 v[208:211], a[168:171], v[48:51], v[208:211]
    v_mul_f32 v165, v165, v103
    v_mul_f32 v166, v166, v103
    v_mul_f32 v167, v167, v103
    v_mul_f32 v172, v172, v103
    v_mul_f32 v173, v173, v103
    v_mul_f32 v174, v174, v103
    v_mul_f32 v175, v175, v103
    v_cvt_pk_bf16_f32 v0, v164, v165
    v_cvt_pk_bf16_f32 v1, v166, v167
    v_cvt_pk_bf16_f32 v2, v172, v173
    v_cvt_pk_bf16_f32 v3, v174, v175
    v_mfma_f32_16x16x32_bf16 v[212:215], a[168:171], v[52:55], v[212:215]
    v_mul_f32 v180, v180, v103
    v_mul_f32 v181, v181, v103
    v_mul_f32 v182, v182, v103
    v_mul_f32 v183, v183, v103
    v_mul_f32 v188, v188, v103
    v_mul_f32 v189, v189, v103
    v_mul_f32 v190, v190, v103
    v_mul_f32 v191, v191, v103
    v_cvt_pk_bf16_f32 v4, v180, v181
    v_cvt_pk_bf16_f32 v5, v182, v183
    v_cvt_pk_bf16_f32 v6, v188, v189
    v_mfma_f32_16x16x32_bf16 v[216:219], a[172:175], v[48:51], v[216:219]
    v_cvt_pk_bf16_f32 v7, v190, v191
    v_permlane16_swap_b32 v0, v2
    v_permlane16_swap_b32 v1, v3
    v_permlane16_swap_b32 v4, v6
    v_permlane16_swap_b32 v5, v7
    v_mov_b32 v8, v0
    v_mov_b32 v9, v1
    v_mov_b32 v10, v2
    v_mov_b32 v11, v3
    v_mov_b32_dpp v0, v4 row_ror:8 row_mask:0xf bank_mask:0xc
    v_mov_b32_dpp v1, v5 row_ror:8 row_mask:0xf bank_mask:0xc
    v_mfma_f32_16x16x32_bf16 v[220:223], a[172:175], v[52:55], v[220:223]
    v_mov_b32_dpp v2, v6 row_ror:8 row_mask:0xf bank_mask:0xc
    v_mov_b32_dpp v3, v7 row_ror:8 row_mask:0xf bank_mask:0xc
    v_mov_b32_dpp v4, v8 row_ror:8 row_mask:0xf bank_mask:0x3
    v_mov_b32_dpp v5, v9 row_ror:8 row_mask:0xf bank_mask:0x3
    v_mov_b32_dpp v6, v10 row_ror:8 row_mask:0xf bank_mask:0x3
    v_mov_b32_dpp v7, v11 row_ror:8 row_mask:0xf bank_mask:0x3
    s_nop 0
    buffer_store_dwordx4 v[0:3], v94, s[32:35], s63 offen offset:128 sc1
    buffer_store_dwordx4 v[4:7], v94, s[32:35], s88 offen offset:128 sc1
    s_waitcnt lgkmcnt(0)
    v_mfma_f32_16x16x32_bf16 v[224:227], a[176:179], v[48:51], v[224:227]
    v_mul_f32 v192, v192, v102
    v_mul_f32 v193, v193, v102
    v_mul_f32 v194, v194, v102
    v_mul_f32 v195, v195, v102
    v_mul_f32 v200, v200, v102
    v_mul_f32 v201, v201, v102
    v_mul_f32 v202, v202, v102
    v_mul_f32 v203, v203, v102
    v_cvt_pk_bf16_f32 v12, v192, v193
    v_cvt_pk_bf16_f32 v13, v194, v195
    v_cvt_pk_bf16_f32 v14, v200, v201
    v_mfma_f32_16x16x32_bf16 v[228:231], a[176:179], v[52:55], v[228:231]
    v_cvt_pk_bf16_f32 v15, v202, v203
    v_mul_f32 v208, v208, v102
    v_mul_f32 v209, v209, v102
    v_mul_f32 v210, v210, v102
    v_mul_f32 v211, v211, v102
    v_mul_f32 v216, v216, v102
    v_mul_f32 v217, v217, v102
    v_mul_f32 v218, v218, v102
    v_mul_f32 v219, v219, v102
    v_cvt_pk_bf16_f32 v16, v208, v209
    v_cvt_pk_bf16_f32 v17, v210, v211
    v_mfma_f32_16x16x32_bf16 v[232:235], a[180:183], v[48:51], v[232:235]
    v_cvt_pk_bf16_f32 v18, v216, v217
    v_cvt_pk_bf16_f32 v19, v218, v219
    v_permlane16_swap_b32 v12, v14
    v_permlane16_swap_b32 v13, v15
    v_permlane16_swap_b32 v16, v18
    v_permlane16_swap_b32 v17, v19
    v_mov_b32 v20, v12
    v_mov_b32 v21, v13
    v_mov_b32 v22, v14
    v_mov_b32 v23, v15
    v_mov_b32_dpp v12, v16 row_ror:8 row_mask:0xf bank_mask:0xc
    v_mfma_f32_16x16x32_bf16 v[236:239], a[180:183], v[52:55], v[236:239]
    v_mov_b32_dpp v13, v17 row_ror:8 row_mask:0xf bank_mask:0xc
    v_mov_b32_dpp v14, v18 row_ror:8 row_mask:0xf bank_mask:0xc
    v_mov_b32_dpp v15, v19 row_ror:8 row_mask:0xf bank_mask:0xc
    v_mov_b32_dpp v16, v20 row_ror:8 row_mask:0xf bank_mask:0x3
    v_mov_b32_dpp v17, v21 row_ror:8 row_mask:0xf bank_mask:0x3
    v_mov_b32_dpp v18, v22 row_ror:8 row_mask:0xf bank_mask:0x3
    v_mov_b32_dpp v19, v23 row_ror:8 row_mask:0xf bank_mask:0x3
    s_nop 0
    buffer_store_dwordx4 v[12:15], v94, s[32:35], s42 offen offset:256 sc1
    buffer_store_dwordx4 v[16:19], v94, s[32:35], s62 offen offset:256 sc1
    v_mul_f32 v196, v196, v103
    v_mfma_f32_16x16x32_bf16 v[240:243], a[184:187], v[48:51], v[240:243]
    v_mul_f32 v197, v197, v103
    v_mul_f32 v198, v198, v103
    v_mul_f32 v199, v199, v103
    v_mul_f32 v204, v204, v103
    v_mul_f32 v205, v205, v103
    v_mul_f32 v206, v206, v103
    v_mul_f32 v207, v207, v103
    v_cvt_pk_bf16_f32 v24, v196, v197
    v_cvt_pk_bf16_f32 v25, v198, v199
    v_cvt_pk_bf16_f32 v26, v204, v205
    v_cvt_pk_bf16_f32 v27, v206, v207
    v_mfma_f32_16x16x32_bf16 v[244:247], a[184:187], v[52:55], v[244:247]
    v_mul_f32 v212, v212, v103
    v_mul_f32 v213, v213, v103
    v_mul_f32 v214, v214, v103
    v_mul_f32 v215, v215, v103
    v_mul_f32 v220, v220, v103
    v_mul_f32 v221, v221, v103
    v_mul_f32 v222, v222, v103
    v_mul_f32 v223, v223, v103
    v_cvt_pk_bf16_f32 v28, v212, v213
    v_cvt_pk_bf16_f32 v29, v214, v215
    v_cvt_pk_bf16_f32 v30, v220, v221
    v_mfma_f32_16x16x32_bf16 v[248:251], a[188:191], v[48:51], v[248:251]
    v_cvt_pk_bf16_f32 v31, v222, v223
    v_permlane16_swap_b32 v24, v26
    v_permlane16_swap_b32 v25, v27
    v_permlane16_swap_b32 v28, v30
    v_permlane16_swap_b32 v29, v31
    v_mov_b32 v32, v24
    v_mov_b32 v33, v25
    v_mov_b32 v34, v26
    v_mov_b32 v35, v27
    v_mov_b32_dpp v24, v28 row_ror:8 row_mask:0xf bank_mask:0xc
    v_mov_b32_dpp v25, v29 row_ror:8 row_mask:0xf bank_mask:0xc
    v_mfma_f32_16x16x32_bf16 v[252:255], a[188:191], v[52:55], v[252:255]
    v_mov_b32_dpp v26, v30 row_ror:8 row_mask:0xf bank_mask:0xc
    v_mov_b32_dpp v27, v31 row_ror:8 row_mask:0xf bank_mask:0xc
    v_mov_b32_dpp v28, v32 row_ror:8 row_mask:0xf bank_mask:0x3
    v_mov_b32_dpp v29, v33 row_ror:8 row_mask:0xf bank_mask:0x3
    v_mov_b32_dpp v30, v34 row_ror:8 row_mask:0xf bank_mask:0x3
    v_mov_b32_dpp v31, v35 row_ror:8 row_mask:0xf bank_mask:0x3
    s_nop 0
    buffer_store_dwordx4 v[24:27], v94, s[32:35], s63 offen offset:256 sc1
    buffer_store_dwordx4 v[28:31], v94, s[32:35], s88 offen offset:256 sc1
    s_nop 3
    v_mul_f32 v224, v224, v102
    v_mul_f32 v225, v225, v102
    v_mul_f32 v226, v226, v102
    v_mul_f32 v227, v227, v102
    v_mul_f32 v232, v232, v102
    v_mul_f32 v233, v233, v102
    v_mul_f32 v234, v234, v102
    v_mul_f32 v235, v235, v102
    v_cvt_pk_bf16_f32 v0, v224, v225
    v_cvt_pk_bf16_f32 v1, v226, v227
    v_cvt_pk_bf16_f32 v2, v232, v233
    v_cvt_pk_bf16_f32 v3, v234, v235
    v_mul_f32 v240, v240, v102
    v_mul_f32 v241, v241, v102
    v_mul_f32 v242, v242, v102
    v_mul_f32 v243, v243, v102
    v_mul_f32 v248, v248, v102
    v_mul_f32 v249, v249, v102
    v_mul_f32 v250, v250, v102
    v_mul_f32 v251, v251, v102
    v_cvt_pk_bf16_f32 v4, v240, v241
    v_cvt_pk_bf16_f32 v5, v242, v243
    v_cvt_pk_bf16_f32 v6, v248, v249
    v_cvt_pk_bf16_f32 v7, v250, v251
    v_permlane16_swap_b32 v0, v2
    v_permlane16_swap_b32 v1, v3
    v_permlane16_swap_b32 v4, v6
    v_permlane16_swap_b32 v5, v7
    v_mov_b32 v8, v0
    v_mov_b32 v9, v1
    v_mov_b32 v10, v2
    v_mov_b32 v11, v3
    v_mov_b32_dpp v0, v4 row_ror:8 row_mask:0xf bank_mask:0xc
    v_mov_b32_dpp v1, v5 row_ror:8 row_mask:0xf bank_mask:0xc
    v_mov_b32_dpp v2, v6 row_ror:8 row_mask:0xf bank_mask:0xc
    v_mov_b32_dpp v3, v7 row_ror:8 row_mask:0xf bank_mask:0xc
    v_mov_b32_dpp v4, v8 row_ror:8 row_mask:0xf bank_mask:0x3
    v_mov_b32_dpp v5, v9 row_ror:8 row_mask:0xf bank_mask:0x3
    v_mov_b32_dpp v6, v10 row_ror:8 row_mask:0xf bank_mask:0x3
    v_mov_b32_dpp v7, v11 row_ror:8 row_mask:0xf bank_mask:0x3
    s_nop 0
    buffer_store_dwordx4 v[0:3], v94, s[32:35], s42 offen offset:384 sc1
    buffer_store_dwordx4 v[4:7], v94, s[32:35], s62 offen offset:384 sc1
    v_mul_f32 v228, v228, v103
    v_mul_f32 v229, v229, v103
    v_mul_f32 v230, v230, v103
    v_mul_f32 v231, v231, v103
    v_mul_f32 v236, v236, v103
    v_mul_f32 v237, v237, v103
    v_mul_f32 v238, v238, v103
    v_mul_f32 v239, v239, v103
    v_cvt_pk_bf16_f32 v12, v228, v229
    v_cvt_pk_bf16_f32 v13, v230, v231
    v_cvt_pk_bf16_f32 v14, v236, v237
    v_cvt_pk_bf16_f32 v15, v238, v239
    v_mul_f32 v244, v244, v103
    v_mul_f32 v245, v245, v103
    v_mul_f32 v246, v246, v103
    v_mul_f32 v247, v247, v103
    v_mul_f32 v252, v252, v103
    v_mul_f32 v253, v253, v103
    v_mul_f32 v254, v254, v103
    v_mul_f32 v255, v255, v103
    v_cvt_pk_bf16_f32 v16, v244, v245
    v_cvt_pk_bf16_f32 v17, v246, v247
    v_cvt_pk_bf16_f32 v18, v252, v253
    v_cvt_pk_bf16_f32 v19, v254, v255
    v_permlane16_swap_b32 v12, v14
    v_permlane16_swap_b32 v13, v15
    v_permlane16_swap_b32 v16, v18
    v_permlane16_swap_b32 v17, v19
    v_mov_b32 v20, v12
    v_mov_b32 v21, v13
    v_mov_b32 v22, v14
    v_mov_b32 v23, v15
    v_mov_b32_dpp v12, v16 row_ror:8 row_mask:0xf bank_mask:0xc
    v_mov_b32_dpp v13, v17 row_ror:8 row_mask:0xf bank_mask:0xc
    v_mov_b32_dpp v14, v18 row_ror:8 row_mask:0xf bank_mask:0xc
    v_mov_b32_dpp v15, v19 row_ror:8 row_mask:0xf bank_mask:0xc
    v_mov_b32_dpp v16, v20 row_ror:8 row_mask:0xf bank_mask:0x3
    v_mov_b32_dpp v17, v21 row_ror:8 row_mask:0xf bank_mask:0x3
    v_mov_b32_dpp v18, v22 row_ror:8 row_mask:0xf bank_mask:0x3
    v_mov_b32_dpp v19, v23 row_ror:8 row_mask:0xf bank_mask:0x3
    s_nop 0
    buffer_store_dwordx4 v[12:15], v94, s[32:35], s63 offen offset:384 sc1
    buffer_store_dwordx4 v[16:19], v94, s[32:35], s88 offen offset:384 sc1
L_epi:
L_end:
    s_endpgm
L_rare0:
    s_nop 15
    v_max3_f32 v100, v16, v17, v18
    v_max3_f32 v102, v19, v24, v25
    v_max3_f32 v101, v20, v21, v22
    v_max3_f32 v103, v23, v28, v29
    v_max3_f32 v100, v100, v26, v27
    v_max3_f32 v101, v101, v30, v31
    v_max_f32 v100, v100, v102
    v_max_f32 v101, v101, v103
    v_mov_b32 v102, v100
    v_mov_b32 v103, v101
    s_nop 1
    v_permlane32_swap_b32 v100, v102
    v_permlane32_swap_b32 v101, v103
    s_nop 1
    v_max_f32 v100, v100, v102
    v_max_f32 v101, v101, v103
    v_mov_b32 v102, v100
    v_mov_b32 v103, v101
    s_nop 1
    v_permlane16_swap_b32 v100, v102
    v_permlane16_swap_b32 v101, v103
    s_nop 1
    v_max_f32 v100, v100, v102
    v_max_f32 v101, v101, v103
    v_add_f32 v100, 0x40400000, v100
    v_add_f32 v101, 0x40400000, v101
    v_max_f32 v100, 0, v100
    v_max_f32 v101, 0, v101
    v_exp_f32_e64 v104, -v100
    v_exp_f32_e64 v105, -v101
    v_sub_f32 v32, v32, v100
    v_sub_f32 v33, v33, v100
    v_sub_f32 v34, v34, v100
    v_sub_f32 v35, v35, v100
    v_sub_f32 v36, v36, v101
    v_sub_f32 v37, v37, v101
    v_sub_f32 v38, v38, v101
    v_sub_f32 v39, v39, v101
    v_sub_f32 v0, v0, v100
    v_sub_f32 v1, v1, v100
    v_sub_f32 v2, v2, v100
    v_sub_f32 v3, v3, v100
    v_sub_f32 v4, v4, v101
    v_sub_f32 v5, v5, v101
    v_sub_f32 v6, v6, v101
    v_sub_f32 v7, v7, v101
    v_sub_f32 v8, v8, v100
    v_sub_f32 v9, v9, v100
    v_sub_f32 v10, v10, v100
    v_sub_f32 v11, v11, v100
    v_sub_f32 v12, v12, v101
    v_sub_f32 v13, v13, v101
    v_sub_f32 v14, v14, v101
    v_sub_f32 v15, v15, v101
    v_sub_f32 v16, v16, v100
    v_sub_f32 v17, v17, v100
    v_sub_f32 v18, v18, v100
    v_sub_f32 v19, v19, v100
    v_sub_f32 v20, v20, v101
    v_sub_f32 v21, v21, v101
    v_sub_f32 v22, v22, v101
    v_sub_f32 v23, v23, v101
    v_sub_f32 v24, v24, v100
    v_sub_f32 v25, v25, v100
    v_sub_f32 v26, v26, v100
    v_sub_f32 v27, v27, v100
    v_sub_f32 v28, v28, v101
    v_sub_f32 v29, v29, v101
    v_sub_f32 v30, v30, v101
    v_sub_f32 v31, v31, v101
    v_mul_f32 v128, v128, v104
    v_mul_f32 v129, v129, v104
    v_mul_f32 v130, v130, v104
    v_mul_f32 v131, v131, v104
    v_mul_f32 v132, v132, v105
    v_mul_f32 v133, v133, v105
    v_mul_f32 v134, v134, v105
    v_mul_f32 v135, v135, v105
    v_mul_f32 v136, v136, v104
    v_mul_f32 v137, v137, v104
    v_mul_f32 v138, v138, v104
    v_mul_f32 v139, v139, v104
    v_mul_f32 v140, v140, v105
    v_mul_f32 v141, v141, v105
    v_mul_f32 v142, v142, v105
    v_mul_f32 v143, v143, v105
    v_mul_f32 v144, v144, v104
    v_mul_f32 v145, v145, v104
    v_mul_f32 v146, v146, v104
    v_mul_f32 v147, v147, v104
    v_mul_f32 v148, v148, v105
    v_mul_f32 v149, v149, v105
    v_mul_f32 v150, v150, v105
    v_mul_f32 v151, v151, v105
    v_mul_f32 v152, v152, v104
    v_mul_f32 v153, v153, v104
    v_mul_f32 v154, v154, v104
    v_mul_f32 v155, v155, v104
    v_mul_f32 v156, v156, v105
    v_mul_f32 v157, v157, v105
    v_mul_f32 v158, v158, v105
    v_mul_f32 v159, v159, v105
    v_mul_f32 v160, v160, v104
    v_mul_f32 v161, v161, v104
    v_mul_f32 v162, v162, v104
    v_mul_f32 v163, v163, v104
    v_mul_f32 v164, v164, v105
    v_mul_f32 v165, v165, v105
    v_mul_f32 v166, v166, v105
    v_mul_f32 v167, v167, v105
    v_mul_f32 v168, v168, v104
    v_mul_f32 v169, v169, v104
    v_mul_f32 v170, v170, v104
    v_mul_f32 v171, v171, v104
    v_mul_f32 v172, v172, v105
    v_mul_f32 v173, v173, v105
    v_mul_f32 v174, v174, v105
    v_mul_f32 v175, v175, v105
    v_mul_f32 v176, v176, v104
    v_mul_f32 v177, v177, v104
    v_mul_f32 v178, v178, v104
    v_mul_f32 v179, v179, v104
    v_mul_f32 v180, v180, v105
    v_mul_f32 v181, v181, v105
    v_mul_f32 v182, v182, v105
    v_mul_f32 v183, v183, v105
    v_mul_f32 v184, v184, v104
    v_mul_f32 v185, v185, v104
    v_mul_f32 v186, v186, v104
    v_mul_f32 v187, v187, v104
    v_mul_f32 v188, v188, v105
    v_mul_f32 v189, v189, v105
    v_mul_f32 v190, v190, v105
    v_mul_f32 v191, v191, v105
    v_mul_f32 v192, v192, v104
    v_mul_f32 v193, v193, v104
    v_mul_f32 v194, v194, v104
    v_mul_f32 v195, v195, v104
    v_mul_f32 v196, v196, v105
    v_mul_f32 v197, v197, v105
    v_mul_f32 v198, v198, v105
    v_mul_f32 v199, v199, v105
    v_mul_f32 v200, v200, v104
    v_mul_f32 v201, v201, v104
    v_mul_f32 v202, v202, v104
    v_mul_f32 v203, v203, v104
    v_mul_f32 v204, v204, v105
    v_mul_f32 v205, v205, v105
    v_mul_f32 v206, v206, v105
    v_mul_f32 v207, v207, v105
    v_mul_f32 v208, v208, v104
    v_mul_f32 v209, v209, v104
    v_mul_f32 v210, v210, v104
    v_mul_f32 v211, v211, v104
    v_mul_f32 v212, v212, v105
    v_mul_f32 v213, v213, v105
    v_mul_f32 v214, v214, v105
    v_mul_f32 v215, v215, v105
    v_mul_f32 v216, v216, v104
    v_mul_f32 v217, v217, v104
    v_mul_f32 v218, v218, v104
    v_mul_f32 v219, v219, v104
    v_mul_f32 v220, v220, v105
    v_mul_f32 v221, v221, v105
    v_mul_f32 v222, v222, v105
    v_mul_f32 v223, v223, v105
    v_mul_f32 v224, v224, v104
    v_mul_f32 v225, v225, v104
    v_mul_f32 v226, v226, v104
    v_mul_f32 v227, v227, v104
    v_mul_f32 v228, v228, v105
    v_mul_f32 v229, v229, v105
    v_mul_f32 v230, v230, v105
    v_mul_f32 v231, v231, v105
    v_mul_f32 v232, v232, v104
    v_mul_f32 v233, v233, v104
    v_mul_f32 v234, v234, v104
    v_mul_f32 v235, v235, v104
    v_mul_f32 v236, v236, v105
    v_mul_f32 v237, v237, v105
    v_mul_f32 v238, v238, v105
    v_mul_f32 v239, v239, v105
    v_mul_f32 v240, v240, v104
    v_mul_f32 v241, v241, v104
    v_mul_f32 v242, v242, v104
    v_mul_f32 v243, v243, v104
    v_mul_f32 v244, v244, v105
    v_mul_f32 v245, v245, v105
    v_mul_f32 v246, v246, v105
    v_mul_f32 v247, v247, v105
    v_mul_f32 v248, v248, v104
    v_mul_f32 v249, v249, v104
    v_mul_f32 v250, v250, v104
    v_mul_f32 v251, v251, v104
    v_mul_f32 v252, v252, v105
    v_mul_f32 v253, v253, v105
    v_mul_f32 v254, v254, v105
    v_mul_f32 v255, v255, v105
    v_mul_f32 v72, v72, v104
    v_mul_f32 v73, v73, v105
    v_exp_f32 v56, v16
    v_exp_f32 v57, v17
    v_exp_f32 v58, v18
    v_exp_f32 v59, v19
    v_exp_f32 v60, v20
    v_exp_f32 v61, v21
    v_exp_f32 v62, v22
    v_exp_f32 v63, v23
    v_exp_f32 v64, v24
    v_exp_f32 v65, v25
    v_exp_f32 v66, v26
    v_exp_f32 v67, v27
    v_exp_f32 v68, v28
    v_exp_f32 v69, v29
    v_exp_f32 v70, v30
    v_exp_f32 v71, v31
    v_add_f32 v74, v56, v57
    v_add_f32 v74, v74, v58
    v_add_f32 v74, v74, v59
    v_add_f32 v75, v60, v61
    v_add_f32 v75, v75, v62
    v_add_f32 v75, v75, v63
    v_add_f32 v74, v74, v64
    v_add_f32 v74, v74, v65
    v_add_f32 v74, v74, v66
    v_add_f32 v74, v74, v67
    v_add_f32 v75, v75, v68
    v_add_f32 v75, v75, v69
    v_add_f32 v75, v75, v70
    v_add_f32 v75, v75, v71
    v_cvt_pk_bf16_f32 v48, v56, v57
    v_cvt_pk_bf16_f32 v49, v58, v59
    v_cvt_pk_bf16_f32 v52, v60, v61
    v_cvt_pk_bf16_f32 v53, v62, v63
    v_cvt_pk_bf16_f32 v50, v64, v65
    v_cvt_pk_bf16_f32 v51, v66, v67
    v_cvt_pk_bf16_f32 v54, v68, v69
    v_cvt_pk_bf16_f32 v55, v70, v71
    v_exp_f32 v56, v0
    v_exp_f32 v57, v1
    s_nop 3
    s_branch L_back0
L_rare1:
    s_nop 15
    v_max3_f32 v100, v0, v1, v2
    v_max3_f32 v102, v3, v8, v9
    v_max3_f32 v101, v4, v5, v6
    v_max3_f32 v103, v7, v12, v13
    v_max3_f32 v100, v100, v10, v11
    v_max3_f32 v101, v101, v14, v15
    v_max_f32 v100, v100, v102
    v_max_f32 v101, v101, v103
    v_mov_b32 v102, v100
    v_mov_b32 v103, v101
    s_nop 1
    v_permlane32_swap_b32 v100, v102
    v_permlane32_swap_b32 v101, v103
    s_nop 1
    v_max_f32 v100, v100, v102
    v_max_f32 v101, v101, v103
    v_mov_b32 v102, v100
    v_mov_b32 v103, v101
    s_nop 1
    v_permlane16_swap_b32 v100, v102
    v_permlane16_swap_b32 v101, v103
    s_nop 1
    v_max_f32 v100, v100, v102
    v_max_f32 v101, v101, v103
    v_add_f32 v100, 0x40400000, v100
    v_add_f32 v101, 0x40400000, v101
    v_max_f32 v100, 0, v100
    v_max_f32 v101, 0, v101
    v_exp_f32_e64 v104, -v100
    v_exp_f32_e64 v105, -v101
    v_sub_f32 v32, v32, v100
    v_sub_f32 v33, v33, v100
    v_sub_f32 v34, v34, v100
    v_sub_f32 v35, v35, v100
    v_sub_f32 v36, v36, v101
    v_sub_f32 v37, v37, v101
    v_sub_f32 v38, v38, v101
    v_sub_f32 v39, v39, v101
    v_sub_f32 v16, v16, v100
    v_sub_f32 v17, v17, v100
    v_sub_f32 v18, v18, v100
    v_sub_f32 v19, v19, v100
    v_sub_f32 v20, v20, v101
    v_sub_f32 v21, v21, v101
    v_sub_f32 v22, v22, v101
    v_sub_f32 v23, v23, v101
    v_sub_f32 v24, v24, v100
    v_sub_f32 v25, v25, v100
    v_sub_f32 v26, v26, v100
    v_sub_f32 v27, v27, v100
    v_sub_f32 v28, v28, v101
    v_sub_f32 v29, v29, v101
    v_sub_f32 v30, v30, v101
    v_sub_f32 v31, v31, v101
    v_sub_f32 v0, v0, v100
    v_sub_f32 v1, v1, v100
    v_sub_f32 v2, v2, v100
    v_sub_f32 v3, v3, v100
    v_sub_f32 v4, v4, v101
    v_sub_f32 v5, v5, v101
    v_sub_f32 v6, v6, v101
    v_sub_f32 v7, v7, v101
    v_sub_f32 v8, v8, v100
    v_sub_f32 v9, v9, v100
    v_sub_f32 v10, v10, v100
    v_sub_f32 v11, v11, v100
    v_sub_f32 v12, v12, v101
    v_sub_f32 v13, v13, v101
    v_sub_f32 v14, v14, v101
    v_sub_f32 v15, v15, v101
    v_mul_f32 v128, v128, v104
    v_mul_f32 v129, v129, v104
    v_mul_f32 v130, v130, v104
    v_mul_f32 v131, v131, v104
    v_mul_f32 v132, v132, v105
    v_mul_f32 v133, v133, v105
    v_mul_f32 v134, v134, v105
    v_mul_f32 v135, v135, v105
    v_mul_f32 v136, v136, v104
    v_mul_f32 v137, v137, v104
    v_mul_f32 v138, v138, v104
    v_mul_f32 v139, v139, v104
    v_mul_f32 v140, v140, v105
    v_mul_f32 v141, v141, v105
    v_mul_f32 v142, v142, v105
    v_mul_f32 v143, v143, v105
    v_mul_f32 v144, v144, v104
    v_mul_f32 v145, v145, v104
    v_mul_f32 v146, v146, v104
    v_mul_f32 v147, v147, v104
    v_mul_f32 v148, v148, v105
    v_mul_f32 v149, v149, v105
    v_mul_f32 v150, v150, v105
    v_mul_f32 v151, v151, v105
    v_mul_f32 v152, v152, v104
    v_mul_f32 v153, v153, v104
    v_mul_f32 v154, v154, v104
    v_mul_f32 v155, v155, v104
    v_mul_f32 v156, v156, v105
    v_mul_f32 v157, v157, v105
    v_mul_f32 v158, v158, v105
    v_mul_f32 v159, v159, v105
    v_mul_f32 v160, v160, v104
    v_mul_f32 v161, v161, v104
    v_mul_f32 v162, v162, v104
    v_mul_f32 v163, v163, v104
    v_mul_f32 v164, v164, v105
    v_mul_f32 v165, v165, v105
    v_mul_f32 v166, v166, v105
    v_mul_f32 v167, v167, v105
    v_mul_f32 v168, v168, v104
    v_mul_f32 v169, v169, v104
    v_mul_f32 v170, v170, v104
    v_mul_f32 v171, v171, v104
    v_mul_f32 v172, v172, v105
    v_mul_f32 v173, v173, v105
    v_mul_f32 v174, v174, v105
    v_mul_f32 v175, v175, v105
    v_mul_f32 v176, v176, v104
    v_mul_f32 v177, v177, v104
    v_mul_f32 v178, v178, v104
    v_mul_f32 v179, v179, v104
    v_mul_f32 v180, v180, v105
    v_mul_f32 v181, v181, v105
    v_mul_f32 v182, v182, v105
    v_mul_f32 v183, v183, v105
    v_mul_f32 v184, v184, v104
    v_mul_f32 v185, v185, v104
    v_mul_f32 v186, v186, v104
    v_mul_f32 v187, v187, v104
    v_mul_f32 v188, v188, v105
    v_mul_f32 v189, v189, v105
    v_mul_f32 v190, v190, v105
    v_mul_f32 v191, v191, v105
    v_mul_f32 v192, v192, v104
    v_mul_f32 v193, v193, v104
    v_mul_f32 v194, v194, v104
    v_mul_f32 v195, v195, v104
    v_mul_f32 v196, v196, v105
    v_mul_f32 v197, v197, v105
    v_mul_f32 v198, v198, v105
    v_mul_f32 v199, v199, v105
    v_mul_f32 v200, v200, v104
    v_mul_f32 v201, v201, v104
    v_mul_f32 v202, v202, v104
    v_mul_f32 v203, v203, v104
    v_mul_f32 v204, v204, v105
    v_mul_f32 v205, v205, v105
    v_mul_f32 v206, v206, v105
    v_mul_f32 v207, v207, v105
    v_mul_f32 v208, v208, v104
    v_mul_f32 v209, v209, v104
    v_mul_f32 v210, v210, v104
    v_mul_f32 v211, v211, v104
    v_mul_f32 v212, v212, v105
    v_mul_f32 v213, v213, v105
    v_mul_f32 v214, v214, v105
    v_mul_f32 v215, v215, v105
    v_mul_f32 v216, v216, v104
    v_mul_f32 v217, v217, v104
    v_mul_f32 v218, v218, v104
    v_mul_f32 v219, v219, v104
    v_mul_f32 v220, v220, v105
    v_mul_f32 v221, v221, v105
    v_mul_f32 v222, v222, v105
    v_mul_f32 v223, v223, v105
    v_mul_f32 v224, v224, v104
    v_mul_f32 v225, v225, v104
    v_mul_f32 v226, v226, v104
    v_mul_f32 v227, v227, v104
    v_mul_f32 v228, v228, v105
    v_mul_f32 v229, v229, v105
    v_mul_f32 v230, v230, v105
    v_mul_f32 v231, v231, v105
    v_mul_f32 v232, v232, v104
    v_mul_f32 v233, v233, v104
    v_mul_f32 v234, v234, v104
    v_mul_f32 v235, v235, v104
    v_mul_f32 v236, v236, v105
    v_mul_f32 v237, v237, v105
    v_mul_f32 v238, v238, v105
    v_mul_f32 v239, v239, v105
    v_mul_f32 v240, v240, v104
    v_mul_f32 v241, v241, v104
    v_mul_f32 v242, v242, v104
    v_mul_f32 v243, v243, v104
    v_mul_f32 v244, v244, v105
    v_mul_f32 v245, v245, v105
    v_mul_f32 v246, v246, v105
    v_mul_f32 v247, v247, v105
    v_mul_f32 v248, v248, v104
    v_mul_f32 v249, v249, v104
    v_mul_f32 v250, v250, v104
    v_mul_f32 v251, v251, v104
    v_mul_f32 v252, v252, v105
    v_mul_f32 v253, v253, v105
    v_mul_f32 v254, v254, v105
    v_mul_f32 v255, v255, v105
    v_mul_f32 v72, v72, v104
    v_mul_f32 v73, v73, v105
    v_exp_f32 v56, v0
    v_exp_f32 v57, v1
    v_exp_f32 v58, v2
    v_exp_f32 v59, v3
    v_exp_f32 v60, v4
    v_exp_f32 v61, v5
    v_exp_f32 v62, v6
    v_exp_f32 v63, v7
    v_exp_f32 v64, v8
    v_exp_f32 v65, v9
    v_exp_f32 v66, v10
    v_exp_f32 v67, v11
    v_exp_f32 v68, v12
    v_exp_f32 v69, v13
    v_exp_f32 v70, v14
    v_exp_f32 v71, v15
    v_add_f32 v74, v56, v57
    v_add_f32 v74, v74, v58
    v_add_f32 v74, v74, v59
    v_add_f32 v75, v60, v61
    v_add_f32 v75, v75, v62
    v_add_f32 v75, v75, v63
    v_add_f32 v74, v74, v64
    v_add_f32 v74, v74, v65
    v_add_f32 v74, v74, v66
    v_add_f32 v74, v74, v67
    v_add_f32 v75, v75, v68
    v_add_f32 v75, v75, v69
    v_add_f32 v75, v75, v70
    v_add_f32 v75, v75, v71
    v_cvt_pk_bf16_f32 v40, v56, v57
    v_cvt_pk_bf16_f32 v41, v58, v59
    v_cvt_pk_bf16_f32 v44, v60, v61
    v_cvt_pk_bf16_f32 v45, v62, v63
    v_cvt_pk_bf16_f32 v42, v64, v65
    v_cvt_pk_bf16_f32 v43, v66, v67
    v_cvt_pk_bf16_f32 v46, v68, v69
    v_cvt_pk_bf16_f32 v47, v70, v71
    v_exp_f32 v56, v16
    v_exp_f32 v57, v17
    s_nop 3
    s_branch L_back1
L_rare2:
    s_nop 15
    v_max3_f32 v100, v16, v17, v18
    v_max3_f32 v102, v19, v24, v25
    v_max3_f32 v101, v20, v21, v22
    v_max3_f32 v103, v23, v28, v29
    v_max3_f32 v100, v100, v26, v27
    v_max3_f32 v101, v101, v30, v31
    v_max_f32 v100, v100, v102
    v_max_f32 v101, v101, v103
    v_mov_b32 v102, v100
    v_mov_b32 v103, v101
    s_nop 1
    v_permlane32_swap_b32 v100, v102
    v_permlane32_swap_b32 v101, v103
    s_nop 1
    v_max_f32 v100, v100, v102
    v_max_f32 v101, v101, v103
    v_mov_b32 v102, v100
    v_mov_b32 v103, v101
    s_nop 1
    v_permlane16_swap_b32 v100, v102
    v_permlane16_swap_b32 v101, v103
    s_nop 1
    v_max_f32 v100, v100, v102
    v_max_f32 v101, v101, v103
    v_add_f32 v100, 0x40400000, v100
    v_add_f32 v101, 0x40400000, v101
    v_max_f32 v100, 0, v100
    v_max_f32 v101, 0, v101
    v_exp_f32_e64 v104, -v100
    v_exp_f32_e64 v105, -v101
    v_sub_f32 v32, v32, v100
    v_sub_f32 v33, v33, v100
    v_sub_f32 v34, v34, v100
    v_sub_f32 v35, v35, v100
    v_sub_f32 v36, v36, v101
    v_sub_f32 v37, v37, v101
    v_sub_f32 v38, v38, v101
    v_sub_f32 v39, v39, v101
    v_sub_f32 v0, v0, v100
    v_sub_f32 v1, v1, v100
    v_sub_f32 v2, v2, v100
    v_sub_f32 v3, v3, v100
    v_sub_f32 v4, v4, v101
    v_sub_f32 v5, v5, v101
    v_sub_f32 v6, v6, v101
    v_sub_f32 v7, v7, v101
    v_sub_f32 v8, v8, v100
    v_sub_f32 v9, v9, v100
    v_sub_f32 v10, v10, v100
    v_sub_f32 v11, v11, v100
    v_sub_f32 v12, v12, v101
    v_sub_f32 v13, v13, v101
    v_sub_f32 v14, v14, v101
    v_sub_f32 v15, v15, v101
    v_sub_f32 v16, v16, v100
    v_sub_f32 v17, v17, v100
    v_sub_f32 v18, v18, v100
    v_sub_f32 v19, v19, v100
    v_sub_f32 v20, v20, v101
    v_sub_f32 v21, v21, v101
    v_sub_f32 v22, v22, v101
    v_sub_f32 v23, v23, v101
    v_sub_f32 v24, v24, v100
    v_sub_f32 v25, v25, v100
    v_sub_f32 v26, v26, v100
    v_sub_f32 v27, v27, v100
    v_sub_f32 v28, v28, v101
    v_sub_f32 v29, v29, v101
    v_sub_f32 v30, v30, v101
    v_sub_f32 v31, v31, v101
    v_mul_f32 v128, v128, v104
    v_mul_f32 v129, v129, v104
    v_mul_f32 v130, v130, v104
    v_mul_f32 v131, v131, v104
    v_mul_f32 v132, v132, v105
    v_mul_f32 v133, v133, v105
    v_mul_f32 v134, v134, v105
    v_mul_f32 v135, v135, v105
    v_mul_f32 v136, v136, v104
    v_mul_f32 v137, v137, v104
    v_mul_f32 v138, v138, v104
    v_mul_f32 v139, v139, v104
    v_mul_f32 v140, v140, v105
    v_mul_f32 v141, v141, v105
    v_mul_f32 v142, v142, v105
    v_mul_f32 v143, v143, v105
    v_mul_f32 v144, v144, v104
    v_mul_f32 v145, v145, v104
    v_mul_f32 v146, v146, v104
    v_mul_f32 v147, v147, v104
    v_mul_f32 v148, v148, v105
    v_mul_f32 v149, v149, v105
    v_mul_f32 v150, v150, v105
    v_mul_f32 v151, v151, v105
    v_mul_f32 v152, v152, v104
    v_mul_f32 v153, v153, v104
    v_mul_f32 v154, v154, v104
    v_mul_f32 v155, v155, v104
    v_mul_f32 v156, v156, v105
    v_mul_f32 v157, v157, v105
    v_mul_f32 v158, v158, v105
    v_mul_f32 v159, v159, v105
    v_mul_f32 v160, v160, v104
    v_mul_f32 v161, v161, v104
    v_mul_f32 v162, v162, v104
    v_mul_f32 v163, v163, v104
    v_mul_f32 v164, v164, v105
    v_mul_f32 v165, v165, v105
    v_mul_f32 v166, v166, v105
    v_mul_f32 v167, v167, v105
    v_mul_f32 v168, v168, v104
    v_mul_f32 v169, v169, v104
    v_mul_f32 v170, v170, v104
    v_mul_f32 v171, v171, v104
    v_mul_f32 v172, v172, v105
    v_mul_f32 v173, v173, v105
    v_mul_f32 v174, v174, v105
    v_mul_f32 v175, v175, v105
    v_mul_f32 v176, v176, v104
    v_mul_f32 v177, v177, v104
    v_mul_f32 v178, v178, v104
    v_mul_f32 v179, v179, v104
    v_mul_f32 v180, v180, v105
    v_mul_f32 v181, v181, v105
    v_mul_f32 v182, v182, v105
    v_mul_f32 v183, v183, v105
    v_mul_f32 v184, v184, v104
    v_mul_f32 v185, v185, v104
    v_mul_f32 v186, v186, v104
    v_mul_f32 v187, v187, v104
    v_mul_f32 v188, v188, v105
    v_mul_f32 v189, v189, v105
    v_mul_f32 v190, v190, v105
    v_mul_f32 v191, v191, v105
    v_mul_f32 v192, v192, v104
    v_mul_f32 v193, v193, v104
    v_mul_f32 v194, v194, v104
    v_mul_f32 v195, v195, v104
    v_mul_f32 v196, v196, v105
    v_mul_f32 v197, v197, v105
    v_mul_f32 v198, v198, v105
    v_mul_f32 v199, v199, v105
    v_mul_f32 v200, v200, v104
    v_mul_f32 v201, v201, v104
    v_mul_f32 v202, v202, v104
    v_mul_f32 v203, v203, v104
    v_mul_f32 v204, v204, v105
    v_mul_f32 v205, v205, v105
    v_mul_f32 v206, v206, v105
    v_mul_f32 v207, v207, v105
    v_mul_f32 v208, v208, v104
    v_mul_f32 v209, v209, v104
    v_mul_f32 v210, v210, v104
    v_mul_f32 v211, v211, v104
    v_mul_f32 v212, v212, v105
    v_mul_f32 v213, v213, v105
    v_mul_f32 v214, v214, v105
    v_mul_f32 v215, v215, v105
    v_mul_f32 v216, v216, v104
    v_mul_f32 v217, v217, v104
    v_mul_f32 v218, v218, v104
    v_mul_f32 v219, v219, v104
    v_mul_f32 v220, v220, v105
    v_mul_f32 v221, v221, v105
    v_mul_f32 v222, v222, v105
    v_mul_f32 v223, v223, v105
    v_mul_f32 v224, v224, v104
    v_mul_f32 v225, v225, v104
    v_mul_f32 v226, v226, v104
    v_mul_f32 v227, v227, v104
    v_mul_f32 v228, v228, v105
    v_mul_f32 v229, v229, v105
    v_mul_f32 v230, v230, v105
    v_mul_f32 v231, v231, v105
    v_mul_f32 v232, v232, v104
    v_mul_f32 v233, v233, v104
    v_mul_f32 v234, v234, v104
    v_mul_f32 v235, v235, v104
    v_mul_f32 v236, v236, v105
    v_mul_f32 v237, v237, v105
    v_mul_f32 v238, v238, v105
    v_mul_f32 v239, v239, v105
    v_mul_f32 v240, v240, v104
    v_mul_f32 v241, v241, v104
    v_mul_f32 v242, v242, v104
    v_mul_f32 v243, v243, v104
    v_mul_f32 v244, v244, v105
    v_mul_f32 v245, v245, v105
    v_mul_f32 v246, v246, v105
    v_mul_f32 v247, v247, v105
    v_mul_f32 v248, v248, v104
    v_mul_f32 v249, v249, v104
    v_mul_f32 v250, v250, v104
    v_mul_f32 v251, v251, v104
    v_mul_f32 v252, v252, v105
    v_mul_f32 v253, v253, v105
    v_mul_f32 v254, v254, v105
    v_mul_f32 v255, v255, v105
    v_mul_f32 v72, v72, v104
    v_mul_f32 v73, v73, v105
    v_exp_f32 v56, v16
    v_exp_f32 v57, v17
    v_exp_f32 v58, v18
    v_exp_f32 v59, v19
    v_exp_f32 v60, v20
    v_exp_f32 v61, v21
    v_exp_f32 v62, v22
    v_exp_f32 v63, v23
    v_exp_f32 v64, v24
    v_exp_f32 v65, v25
    v_exp_f32 v66, v26
    v_exp_f32 v67, v27
    v_exp_f32 v68, v28
    v_exp_f32 v69, v29
    v_exp_f32 v70, v30
    v_exp_f32 v71, v31
    v_add_f32 v74, v56, v57
    v_add_f32 v74, v74, v58
    v_add_f32 v74, v74, v59
    v_add_f32 v75, v60, v61
    v_add_f32 v75, v75, v62
    v_add_f32 v75, v75, v63
    v_add_f32 v74, v74, v64
    v_add_f32 v74, v74, v65
    v_add_f32 v74, v74, v66
    v_add_f32 v74, v74, v67
    v_add_f32 v75, v75, v68
    v_add_f32 v75, v75, v69
    v_add_f32 v75, v75, v70
    v_add_f32 v75, v75, v71
    v_cvt_pk_bf16_f32 v48, v56, v57
    v_cvt_pk_bf16_f32 v49, v58, v59
    v_cvt_pk_bf16_f32 v52, v60, v61
    v_cvt_pk_bf16_f32 v53, v62, v63
    v_cvt_pk_bf16_f32 v50, v64, v65
    v_cvt_pk_bf16_f32 v51, v66, v67
    v_cvt_pk_bf16_f32 v54, v68, v69
    v_cvt_pk_bf16_f32 v55, v70, v71
    v_exp_f32 v56, v0
    v_exp_f32 v57, v1
    s_nop 3
    s_branch L_back2
L_rare3:
    s_nop 15
    v_max3_f32 v100, v0, v1, v2
    v_max3_f32 v102, v3, v8, v9
    v_max3_f32 v101, v4, v5, v6
    v_max3_f32 v103, v7, v12, v13
    v_max3_f32 v100, v100, v10, v11
    v_max3_f32 v101, v101, v14, v15
    v_max_f32 v100, v100, v102
    v_max_f32 v101, v101, v103
    v_mov_b32 v102, v100
    v_mov_b32 v103, v101
    s_nop 1
    v_permlane32_swap_b32 v100, v102
    v_permlane32_swap_b32 v101, v103
    s_nop 1
    v_max_f32 v100, v100, v102
    v_max_f32 v101, v101, v103
    v_mov_b32 v102, v100
    v_mov_b32 v103, v101
    s_nop 1
    v_permlane16_swap_b32 v100, v102
    v_permlane16_swap_b32 v101, v103
    s_nop 1
    v_max_f32 v100, v100, v102
    v_max_f32 v101, v101, v103
    v_add_f32 v100, 0x40400000, v100
    v_add_f32 v101, 0x40400000, v101
    v_max_f32 v100, 0, v100
    v_max_f32 v101, 0, v101
    v_exp_f32_e64 v104, -v100
    v_exp_f32_e64 v105, -v101
    v_sub_f32 v32, v32, v100
    v_sub_f32 v33, v33, v100
    v_sub_f32 v34, v34, v100
    v_sub_f32 v35, v35, v100
    v_sub_f32 v36, v36, v101
    v_sub_f32 v37, v37, v101
    v_sub_f32 v38, v38, v101
    v_sub_f32 v39, v39, v101
    v_sub_f32 v16, v16, v100
    v_sub_f32 v17, v17, v100
    v_sub_f32 v18, v18, v100
    v_sub_f32 v19, v19, v100
    v_sub_f32 v20, v20, v101
    v_sub_f32 v21, v21, v101
    v_sub_f32 v22, v22, v101
    v_sub_f32 v23, v23, v101
    v_sub_f32 v24, v24, v100
    v_sub_f32 v25, v25, v100
    v_sub_f32 v26, v26, v100
    v_sub_f32 v27, v27, v100
    v_sub_f32 v28, v28, v101
    v_sub_f32 v29, v29, v101
    v_sub_f32 v30, v30, v101
    v_sub_f32 v31, v31, v101
    v_sub_f32 v0, v0, v100
    v_sub_f32 v1, v1, v100
    v_sub_f32 v2, v2, v100
    v_sub_f32 v3, v3, v100
    v_sub_f32 v4, v4, v101
    v_sub_f32 v5, v5, v101
    v_sub_f32 v6, v6, v101
    v_sub_f32 v7, v7, v101
    v_sub_f32 v8, v8, v100
    v_sub_f32 v9, v9, v100
    v_sub_f32 v10, v10, v100
    v_sub_f32 v11, v11, v100
    v_sub_f32 v12, v12, v101
    v_sub_f32 v13, v13, v101
    v_sub_f32 v14, v14, v101
    v_sub_f32 v15, v15, v101
    v_mul_f32 v128, v128, v104
    v_mul_f32 v129, v129, v104
    v_mul_f32 v130, v130, v104
    v_mul_f32 v131, v131, v104
    v_mul_f32 v132, v132, v105
    v_mul_f32 v133, v133, v105
    v_mul_f32 v134, v134, v105
    v_mul_f32 v135, v135, v105
    v_mul_f32 v136, v136, v104
    v_mul_f32 v137, v137, v104
    v_mul_f32 v138, v138, v104
    v_mul_f32 v139, v139, v104
    v_mul_f32 v140, v140, v105
    v_mul_f32 v141, v141, v105
    v_mul_f32 v142, v142, v105
    v_mul_f32 v143, v143, v105
    v_mul_f32 v144, v144, v104
    v_mul_f32 v145, v145, v104
    v_mul_f32 v146, v146, v104
    v_mul_f32 v147, v147, v104
    v_mul_f32 v148, v148, v105
    v_mul_f32 v149, v149, v105
    v_mul_f32 v150, v150, v105
    v_mul_f32 v151, v151, v105
    v_mul_f32 v152, v152, v104
    v_mul_f32 v153, v153, v104
    v_mul_f32 v154, v154, v104
    v_mul_f32 v155, v155, v104
    v_mul_f32 v156, v156, v105
    v_mul_f32 v157, v157, v105
    v_mul_f32 v158, v158, v105
    v_mul_f32 v159, v159, v105
    v_mul_f32 v160, v160, v104
    v_mul_f32 v161, v161, v104
    v_mul_f32 v162, v162, v104
    v_mul_f32 v163, v163, v104
    v_mul_f32 v164, v164, v105
    v_mul_f32 v165, v165, v105
    v_mul_f32 v166, v166, v105
    v_mul_f32 v167, v167, v105
    v_mul_f32 v168, v168, v104
    v_mul_f32 v169, v169, v104
    v_mul_f32 v170, v170, v104
    v_mul_f32 v171, v171, v104
    v_mul_f32 v172, v172, v105
    v_mul_f32 v173, v173, v105
    v_mul_f32 v174, v174, v105
    v_mul_f32 v175, v175, v105
    v_mul_f32 v176, v176, v104
    v_mul_f32 v177, v177, v104
    v_mul_f32 v178, v178, v104
    v_mul_f32 v179, v179, v104
    v_mul_f32 v180, v180, v105
    v_mul_f32 v181, v181, v105
    v_mul_f32 v182, v182, v105
    v_mul_f32 v183, v183, v105
    v_mul_f32 v184, v184, v104
    v_mul_f32 v185, v185, v104
    v_mul_f32 v186, v186, v104
    v_mul_f32 v187, v187, v104
    v_mul_f32 v188, v188, v105
    v_mul_f32 v189, v189, v105
    v_mul_f32 v190, v190, v105
    v_mul_f32 v191, v191, v105
    v_mul_f32 v192, v192, v104
    v_mul_f32 v193, v193, v104
    v_mul_f32 v194, v194, v104
    v_mul_f32 v195, v195, v104
    v_mul_f32 v196, v196, v105
    v_mul_f32 v197, v197, v105
    v_mul_f32 v198, v198, v105
    v_mul_f32 v199, v199, v105
    v_mul_f32 v200, v200, v104
    v_mul_f32 v201, v201, v104
    v_mul_f32 v202, v202, v104
    v_mul_f32 v203, v203, v104
    v_mul_f32 v204, v204, v105
    v_mul_f32 v205, v205, v105
    v_mul_f32 v206, v206, v105
    v_mul_f32 v207, v207, v105
    v_mul_f32 v208, v208, v104
    v_mul_f32 v209, v209, v104
    v_mul_f32 v210, v210, v104
    v_mul_f32 v211, v211, v104
    v_mul_f32 v212, v212, v105
    v_mul_f32 v213, v213, v105
    v_mul_f32 v214, v214, v105
    v_mul_f32 v215, v215, v105
    v_mul_f32 v216, v216, v104
    v_mul_f32 v217, v217, v104
    v_mul_f32 v218, v218, v104
    v_mul_f32 v219, v219, v104
    v_mul_f32 v220, v220, v105
    v_mul_f32 v221, v221, v105
    v_mul_f32 v222, v222, v105
    v_mul_f32 v223, v223, v105
    v_mul_f32 v224, v224, v104
    v_mul_f32 v225, v225, v104
    v_mul_f32 v226, v226, v104
    v_mul_f32 v227, v227, v104
    v_mul_f32 v228, v228, v105
    v_mul_f32 v229, v229, v105
    v_mul_f32 v230, v230, v105
    v_mul_f32 v231, v231, v105
    v_mul_f32 v232, v232, v104
    v_mul_f32 v233, v233, v104
    v_mul_f32 v234, v234, v104
    v_mul_f32 v235, v235, v104
    v_mul_f32 v236, v236, v105
    v_mul_f32 v237, v237, v105
    v_mul_f32 v238, v238, v105
    v_mul_f32 v239, v239, v105
    v_mul_f32 v240, v240, v104
    v_mul_f32 v241, v241, v104
    v_mul_f32 v242, v242, v104
    v_mul_f32 v243, v243, v104
    v_mul_f32 v244, v244, v105
    v_mul_f32 v245, v245, v105
    v_mul_f32 v246, v246, v105
    v_mul_f32 v247, v247, v105
    v_mul_f32 v248, v248, v104
    v_mul_f32 v249, v249, v104
    v_mul_f32 v250, v250, v104
    v_mul_f32 v251, v251, v104
    v_mul_f32 v252, v252, v105
    v_mul_f32 v253, v253, v105
    v_mul_f32 v254, v254, v105
    v_mul_f32 v255, v255, v105
    v_mul_f32 v72, v72, v104
    v_mul_f32 v73, v73, v105
    v_exp_f32 v56, v0
    v_exp_f32 v57, v1
    v_exp_f32 v58, v2
    v_exp_f32 v59, v3
    v_exp_f32 v60, v4
    v_exp_f32 v61, v5
    v_exp_f32 v62, v6
    v_exp_f32 v63, v7
    v_exp_f32 v64, v8
    v_exp_f32 v65, v9
    v_exp_f32 v66, v10
    v_exp_f32 v67, v11
    v_exp_f32 v68, v12
    v_exp_f32 v69, v13
    v_exp_f32 v70, v14
    v_exp_f32 v71, v15
    v_add_f32 v74, v56, v57
    v_add_f32 v74, v74, v58
    v_add_f32 v74, v74, v59
    v_add_f32 v75, v60, v61
    v_add_f32 v75, v75, v62
    v_add_f32 v75, v75, v63
    v_add_f32 v74, v74, v64
    v_add_f32 v74, v74, v65
    v_add_f32 v74, v74, v66
    v_add_f32 v74, v74, v67
    v_add_f32 v75, v75, v68
    v_add_f32 v75, v75, v69
    v_add_f32 v75, v75, v70
    v_add_f32 v75, v75, v71
    v_cvt_pk_bf16_f32 v40, v56, v57
    v_cvt_pk_bf16_f32 v41, v58, v59
    v_cvt_pk_bf16_f32 v44, v60, v61
    v_cvt_pk_bf16_f32 v45, v62, v63
    v_cvt_pk_bf16_f32 v42, v64, v65
    v_cvt_pk_bf16_f32 v43, v66, v67
    v_cvt_pk_bf16_f32 v46, v68, v69
    v_cvt_pk_bf16_f32 v47, v70, v71
    v_exp_f32 v56, v16
    v_exp_f32 v57, v17
    s_nop 3
    s_branch L_back3
L_raret0:
    s_nop 15
    v_max3_f32 v100, v16, v17, v18
    v_max3_f32 v102, v19, v24, v25
    v_max3_f32 v101, v20, v21, v22
    v_max3_f32 v103, v23, v28, v29
    v_max3_f32 v100, v100, v26, v27
    v_max3_f32 v101, v101, v30, v31
    v_max_f32 v100, v100, v102
    v_max_f32 v101, v101, v103
    v_mov_b32 v102, v100
    v_mov_b32 v103, v101
    s_nop 1
    v_permlane32_swap_b32 v100, v102
    v_permlane32_swap_b32 v101, v103
    s_nop 1
    v_max_f32 v100, v100, v102
    v_max_f32 v101, v101, v103
    v_mov_b32 v102, v100
    v_mov_b32 v103, v101
    s_nop 1
    v_permlane16_swap_b32 v100, v102
    v_permlane16_swap_b32 v101, v103
    s_nop 1
    v_max_f32 v100, v100, v102
    v_max_f32 v101, v101, v103
    v_add_f32 v100, 0x40400000, v100
    v_add_f32 v101, 0x40400000, v101
    v_max_f32 v100, 0, v100
    v_max_f32 v101, 0, v101
    v_exp_f32_e64 v104, -v100
    v_exp_f32_e64 v105, -v101
    v_sub_f32 v32, v32, v100
    v_sub_f32 v33, v33, v100
    v_sub_f32 v34, v34, v100
    v_sub_f32 v35, v35, v100
    v_sub_f32 v36, v36, v101
    v_sub_f32 v37, v37, v101
    v_sub_f32 v38, v38, v101
    v_sub_f32 v39, v39, v101
    v_sub_f32 v0, v0, v100
    v_sub_f32 v1, v1, v100
    v_sub_f32 v2, v2, v100
    v_sub_f32 v3, v3, v100
    v_sub_f32 v4, v4, v101
    v_sub_f32 v5, v5, v101
    v_sub_f32 v6, v6, v101
    v_sub_f32 v7, v7, v101
    v_sub_f32 v8, v8, v100
    v_sub_f32 v9, v9, v100
    v_sub_f32 v10, v10, v100
    v_sub_f32 v11, v11, v100
    v_sub_f32 v12, v12, v101
    v_sub_f32 v13, v13, v101
    v_sub_f32 v14, v14, v101
    v_sub_f32 v15, v15, v101
    v_sub_f32 v16, v16, v100
    v_sub_f32 v17, v17, v100
    v_sub_f32 v18, v18, v100
    v_sub_f32 v19, v19, v100
    v_sub_f32 v20, v20, v101
    v_sub_f32 v21, v21, v101
    v_sub_f32 v22, v22, v101
    v_sub_f32 v23, v23, v101
    v_sub_f32 v24, v24, v100
    v_sub_f32 v25, v25, v100
    v_sub_f32 v26, v26, v100
    v_sub_f32 v27, v27, v100
    v_sub_f32 v28, v28, v101
    v_sub_f32 v29, v29, v101
    v_sub_f32 v30, v30, v101
    v_sub_f32 v31, v31, v101
    v_mul_f32 v128, v128, v104
    v_mul_f32 v129, v129, v104
    v_mul_f32 v130, v130, v104
    v_mul_f32 v131, v131, v104
    v_mul_f32 v132, v132, v105
    v_mul_f32 v133, v133, v105
    v_mul_f32 v134, v134, v105
    v_mul_f32 v135, v135, v105
    v_mul_f32 v136, v136, v104
    v_mul_f32 v137, v137, v104
    v_mul_f32 v138, v138, v104
    v_mul_f32 v139, v139, v104
    v_mul_f32 v140, v140, v105
    v_mul_f32 v141, v141, v105
    v_mul_f32 v142, v142, v105
    v_mul_f32 v143, v143, v105
    v_mul_f32 v144, v144, v104
    v_mul_f32 v145, v145, v104
    v_mul_f32 v146, v146, v104
    v_mul_f32 v147, v147, v104
    v_mul_f32 v148, v148, v105
    v_mul_f32 v149, v149, v105
    v_mul_f32 v150, v150, v105
    v_mul_f32 v151, v151, v105
    v_mul_f32 v152, v152, v104
    v_mul_f32 v153, v153, v104
    v_mul_f32 v154, v154, v104
    v_mul_f32 v155, v155, v104
    v_mul_f32 v156, v156, v105
    v_mul_f32 v157, v157, v105
    v_mul_f32 v158, v158, v105
    v_mul_f32 v159, v159, v105
    v_mul_f32 v160, v160, v104
    v_mul_f32 v161, v161, v104
    v_mul_f32 v162, v162, v104
    v_mul_f32 v163, v163, v104
    v_mul_f32 v164, v164, v105
    v_mul_f32 v165, v165, v105
    v_mul_f32 v166, v166, v105
    v_mul_f32 v167, v167, v105
    v_mul_f32 v168, v168, v104
    v_mul_f32 v169, v169, v104
    v_mul_f32 v170, v170, v104
    v_mul_f32 v171, v171, v104
    v_mul_f32 v172, v172, v105
    v_mul_f32 v173, v173, v105
    v_mul_f32 v174, v174, v105
    v_mul_f32 v175, v175, v105
    v_mul_f32 v176, v176, v104
    v_mul_f32 v177, v177, v104
    v_mul_f32 v178, v178, v104
    v_mul_f32 v179, v179, v104
    v_mul_f32 v180, v180, v105
    v_mul_f32 v181, v181, v105
    v_mul_f32 v182, v182, v105
    v_mul_f32 v183, v183, v105
    v_mul_f32 v184, v184, v104
    v_mul_f32 v185, v185, v104
    v_mul_f32 v186, v186, v104
    v_mul_f32 v187, v187, v104
    v_mul_f32 v188, v188, v105
    v_mul_f32 v189, v189, v105
    v_mul_f32 v190, v190, v105
    v_mul_f32 v191, v191, v105
    v_mul_f32 v192, v192, v104
    v_mul_f32 v193, v193, v104
    v_mul_f32 v194, v194, v104
    v_mul_f32 v195, v195, v104
    v_mul_f32 v196, v196, v105
    v_mul_f32 v197, v197, v105
    v_mul_f32 v198, v198, v105
    v_mul_f32 v199, v199, v105
    v_mul_f32 v200, v200, v104
    v_mul_f32 v201, v201, v104
    v_mul_f32 v202, v202, v104
    v_mul_f32 v203, v203, v104
    v_mul_f32 v204, v204, v105
    v_mul_f32 v205, v205, v105
    v_mul_f32 v206, v206, v105
    v_mul_f32 v207, v207, v105
    v_mul_f32 v208, v208, v104
    v_mul_f32 v209, v209, v104
    v_mul_f32 v210, v210, v104
    v_mul_f32 v211, v211, v104
    v_mul_f32 v212, v212, v105
    v_mul_f32 v213, v213, v105
    v_mul_f32 v214, v214, v105
    v_mul_f32 v215, v215, v105
    v_mul_f32 v216, v216, v104
    v_mul_f32 v217, v217, v104
    v_mul_f32 v218, v218, v104
    v_mul_f32 v219, v219, v104
    v_mul_f32 v220, v220, v105
    v_mul_f32 v221, v221, v105
    v_mul_f32 v222, v222, v105
    v_mul_f32 v223, v223, v105
    v_mul_f32 v224, v224, v104
    v_mul_f32 v225, v225, v104
    v_mul_f32 v226, v226, v104
    v_mul_f32 v227, v227, v104
    v_mul_f32 v228, v228, v105
    v_mul_f32 v229, v229, v105
    v_mul_f32 v230, v230, v105
    v_mul_f32 v231, v231, v105
    v_mul_f32 v232, v232, v104
    v_mul_f32 v233, v233, v104
    v_mul_f32 v234, v234, v104
    v_mul_f32 v235, v235, v104
    v_mul_f32 v236, v236, v105
    v_mul_f32 v237, v237, v105
    v_mul_f32 v238, v238, v105
    v_mul_f32 v239, v239, v105
    v_mul_f32 v240, v240, v104
    v_mul_f32 v241, v241, v104
    v_mul_f32 v242, v242, v104
    v_mul_f32 v243, v243, v104
    v_mul_f32 v244, v244, v105
    v_mul_f32 v245, v245, v105
    v_mul_f32 v246, v246, v105
    v_mul_f32 v247, v247, v105
    v_mul_f32 v248, v248, v104
    v_mul_f32 v249, v249, v104
    v_mul_f32 v250, v250, v104
    v_mul_f32 v251, v251, v104
    v_mul_f32 v252, v252, v105
    v_mul_f32 v253, v253, v105
    v_mul_f32 v254, v254, v105
    v_mul_f32 v255, v255, v105
    v_mul_f32 v72, v72, v104
    v_mul_f32 v73, v73, v105
    v_exp_f32 v56, v16
    v_exp_f32 v57, v17
    v_exp_f32 v58, v18
    v_exp_f32 v59, v19
    v_exp_f32 v60, v20
    v_exp_f32 v61, v21
    v_exp_f32 v62, v22
    v_exp_f32 v63, v23
    v_exp_f32 v64, v24
    v_exp_f32 v65, v25
    v_exp_f32 v66, v26
    v_exp_f32 v67, v27
    v_exp_f32 v68, v28
    v_exp_f32 v69, v29
    v_exp_f32 v70, v30
    v_exp_f32 v71, v31
    v_add_f32 v74, v56, v57
    v_add_f32 v74, v74, v58
    v_add_f32 v74, v74, v59
    v_add_f32 v75, v60, v61
    v_add_f32 v75, v75, v62
    v_add_f32 v75, v75, v63
    v_add_f32 v74, v74, v64
    v_add_f32 v74, v74, v65
    v_add_f32 v74, v74, v66
    v_add_f32 v74, v74, v67
    v_add_f32 v75, v75, v68
    v_add_f32 v75, v75, v69
    v_add_f32 v75, v75, v70
    v_add_f32 v75, v75, v71
    v_cvt_pk_bf16_f32 v48, v56, v57
    v_cvt_pk_bf16_f32 v49, v58, v59
    v_cvt_pk_bf16_f32 v52, v60, v61
    v_cvt_pk_bf16_f32 v53, v62, v63
    v_cvt_pk_bf16_f32 v50, v64, v65
    v_cvt_pk_bf16_f32 v51, v66, v67
    v_cvt_pk_bf16_f32 v54, v68, v69
    v_cvt_pk_bf16_f32 v55, v70, v71
    s_nop 3
    s_branch L_backt0
L_raret1:
    s_nop 15
    v_max3_f32 v100, v0, v1, v2
    v_max3_f32 v102, v3, v8, v9
    v_max3_f32 v101, v4, v5, v6
    v_max3_f32 v103, v7, v12, v13
    v_max3_f32 v100, v100, v10, v11
    v_max3_f32 v101, v101, v14, v15
    v_max_f32 v100, v100, v102
    v_max_f32 v101, v101, v103
    v_mov_b32 v102, v100
    v_mov_b32 v103, v101
    s_nop 1
    v_permlane32_swap_b32 v100, v102
    v_permlane32_swap_b32 v101, v103
    s_nop 1
    v_max_f32 v100, v100, v102
    v_max_f32 v101, v101, v103
    v_mov_b32 v102, v100
    v_mov_b32 v103, v101
    s_nop 1
    v_permlane16_swap_b32 v100, v102
    v_permlane16_swap_b32 v101, v103
    s_nop 1
    v_max_f32 v100, v100, v102
    v_max_f32 v101, v101, v103
    v_add_f32 v100, 0x40400000, v100
    v_add_f32 v101, 0x40400000, v101
    v_max_f32 v100, 0, v100
    v_max_f32 v101, 0, v101
    v_exp_f32_e64 v104, -v100
    v_exp_f32_e64 v105, -v101
    v_sub_f32 v32, v32, v100
    v_sub_f32 v33, v33, v100
    v_sub_f32 v34, v34, v100
    v_sub_f32 v35, v35, v100
    v_sub_f32 v36, v36, v101
    v_sub_f32 v37, v37, v101
    v_sub_f32 v38, v38, v101
    v_sub_f32 v39, v39, v101
    v_sub_f32 v16, v16, v100
    v_sub_f32 v17, v17, v100
    v_sub_f32 v18, v18, v100
    v_sub_f32 v19, v19, v100
    v_sub_f32 v20, v20, v101
    v_sub_f32 v21, v21, v101
    v_sub_f32 v22, v22, v101
    v_sub_f32 v23, v23, v101
    v_sub_f32 v24, v24, v100
    v_sub_f32 v25, v25, v100
    v_sub_f32 v26, v26, v100
    v_sub_f32 v27, v27, v100
    v_sub_f32 v28, v28, v101
    v_sub_f32 v29, v29, v101
    v_sub_f32 v30, v30, v101
    v_sub_f32 v31, v31, v101
    v_sub_f32 v0, v0, v100
    v_sub_f32 v1, v1, v100
    v_sub_f32 v2, v2, v100
    v_sub_f32 v3, v3, v100
    v_sub_f32 v4, v4, v101
    v_sub_f32 v5, v5, v101
    v_sub_f32 v6, v6, v101
    v_sub_f32 v7, v7, v101
    v_sub_f32 v8, v8, v100
    v_sub_f32 v9, v9, v100
    v_sub_f32 v10, v10, v100
    v_sub_f32 v11, v11, v100
    v_sub_f32 v12, v12, v101
    v_sub_f32 v13, v13, v101
    v_sub_f32 v14, v14, v101
    v_sub_f32 v15, v15, v101
    v_mul_f32 v128, v128, v104
    v_mul_f32 v129, v129, v104
    v_mul_f32 v130, v130, v104
    v_mul_f32 v131, v131, v104
    v_mul_f32 v132, v132, v105
    v_mul_f32 v133, v133, v105
    v_mul_f32 v134, v134, v105
    v_mul_f32 v135, v135, v105
    v_mul_f32 v136, v136, v104
    v_mul_f32 v137, v137, v104
    v_mul_f32 v138, v138, v104
    v_mul_f32 v139, v139, v104
    v_mul_f32 v140, v140, v105
    v_mul_f32 v141, v141, v105
    v_mul_f32 v142, v142, v105
    v_mul_f32 v143, v143, v105
    v_mul_f32 v144, v144, v104
    v_mul_f32 v145, v145, v104
    v_mul_f32 v146, v146, v104
    v_mul_f32 v147, v147, v104
    v_mul_f32 v148, v148, v105
    v_mul_f32 v149, v149, v105
    v_mul_f32 v150, v150, v105
    v_mul_f32 v151, v151, v105
    v_mul_f32 v152, v152, v104
    v_mul_f32 v153, v153, v104
    v_mul_f32 v154, v154, v104
    v_mul_f32 v155, v155, v104
    v_mul_f32 v156, v156, v105
    v_mul_f32 v157, v157, v105
    v_mul_f32 v158, v158, v105
    v_mul_f32 v159, v159, v105
    v_mul_f32 v160, v160, v104
    v_mul_f32 v161, v161, v104
    v_mul_f32 v162, v162, v104
    v_mul_f32 v163, v163, v104
    v_mul_f32 v164, v164, v105
    v_mul_f32 v165, v165, v105
    v_mul_f32 v166, v166, v105
    v_mul_f32 v167, v167, v105
    v_mul_f32 v168, v168, v104
    v_mul_f32 v169, v169, v104
    v_mul_f32 v170, v170, v104
    v_mul_f32 v171, v171, v104
    v_mul_f32 v172, v172, v105
    v_mul_f32 v173, v173, v105
    v_mul_f32 v174, v174, v105
    v_mul_f32 v175, v175, v105
    v_mul_f32 v176, v176, v104
    v_mul_f32 v177, v177, v104
    v_mul_f32 v178, v178, v104
    v_mul_f32 v179, v179, v104
    v_mul_f32 v180, v180, v105
    v_mul_f32 v181, v181, v105
    v_mul_f32 v182, v182, v105
    v_mul_f32 v183, v183, v105
    v_mul_f32 v184, v184, v104
    v_mul_f32 v185, v185, v104
    v_mul_f32 v186, v186, v104
    v_mul_f32 v187, v187, v104
    v_mul_f32 v188, v188, v105
    v_mul_f32 v189, v189, v105
    v_mul_f32 v190, v190, v105
    v_mul_f32 v191, v191, v105
    v_mul_f32 v192, v192, v104
    v_mul_f32 v193, v193, v104
    v_mul_f32 v194, v194, v104
    v_mul_f32 v195, v195, v104
    v_mul_f32 v196, v196, v105
    v_mul_f32 v197, v197, v105
    v_mul_f32 v198, v198, v105
    v_mul_f32 v199, v199, v105
    v_mul_f32 v200, v200, v104
    v_mul_f32 v201, v201, v104
    v_mul_f32 v202, v202, v104
    v_mul_f32 v203, v203, v104
    v_mul_f32 v204, v204, v105
    v_mul_f32 v205, v205, v105
    v_mul_f32 v206, v206, v105
    v_mul_f32 v207, v207, v105
    v_mul_f32 v208, v208, v104
    v_mul_f32 v209, v209, v104
    v_mul_f32 v210, v210, v104
    v_mul_f32 v211, v211, v104
    v_mul_f32 v212, v212, v105
    v_mul_f32 v213, v213, v105
    v_mul_f32 v214, v214, v105
    v_mul_f32 v215, v215, v105
    v_mul_f32 v216, v216, v104
    v_mul_f32 v217, v217, v104
    v_mul_f32 v218, v218, v104
    v_mul_f32 v219, v219, v104
    v_mul_f32 v220, v220, v105
    v_mul_f32 v221, v221, v105
    v_mul_f32 v222, v222, v105
    v_mul_f32 v223, v223, v105
    v_mul_f32 v224, v224, v104
    v_mul_f32 v225, v225, v104
    v_mul_f32 v226, v226, v104
    v_mul_f32 v227, v227, v104
    v_mul_f32 v228, v228, v105
    v_mul_f32 v229, v229, v105
    v_mul_f32 v230, v230, v105
    v_mul_f32 v231, v231, v105
    v_mul_f32 v232, v232, v104
    v_mul_f32 v233, v233, v104
    v_mul_f32 v234, v234, v104
    v_mul_f32 v235, v235, v104
    v_mul_f32 v236, v236, v105
    v_mul_f32 v237, v237, v105
    v_mul_f32 v238, v238, v105
    v_mul_f32 v239, v239, v105
    v_mul_f32 v240, v240, v104
    v_mul_f32 v241, v241, v104
    v_mul_f32 v242, v242, v104
    v_mul_f32 v243, v243, v104
    v_mul_f32 v244, v244, v105
    v_mul_f32 v245, v245, v105
    v_mul_f32 v246, v246, v105
    v_mul_f32 v247, v247, v105
    v_mul_f32 v248, v248, v104
    v_mul_f32 v249, v249, v104
    v_mul_f32 v250, v250, v104
    v_mul_f32 v251, v251, v104
    v_mul_f32 v252, v252, v105
    v_mul_f32 v253, v253, v105
    v_mul_f32 v254, v254, v105
    v_mul_f32 v255, v255, v105
    v_mul_f32 v72, v72, v104
    v_mul_f32 v73, v73, v105
    v_exp_f32 v56, v0
    v_exp_f32 v57, v1
    v_exp_f32 v58, v2
    v_exp_f32 v59, v3
    v_exp_f32 v60, v4
    v_exp_f32 v61, v5
    v_exp_f32 v62, v6
    v_exp_f32 v63, v7
    v_exp_f32 v64, v8
    v_exp_f32 v65, v9
    v_exp_f32 v66, v10
    v_exp_f32 v67, v11
    v_exp_f32 v68, v12
    v_exp_f32 v69, v13
    v_exp_f32 v70, v14
    v_exp_f32 v71, v15
    v_add_f32 v74, v56, v57
    v_add_f32 v74, v74, v58
    v_add_f32 v74, v74, v59
    v_add_f32 v75, v60, v61
    v_add_f32 v75, v75, v62
    v_add_f32 v75, v75, v63
    v_add_f32 v74, v74, v64
    v_add_f32 v74, v74, v65
    v_add_f32 v74, v74, v66
    v_add_f32 v74, v74, v67
    v_add_f32 v75, v75, v68
    v_add_f32 v75, v75, v69
    v_add_f32 v75, v75, v70
    v_add_f32 v75, v75, v71
    v_cvt_pk_bf16_f32 v40, v56, v57
    v_cvt_pk_bf16_f32 v41, v58, v59
    v_cvt_pk_bf16_f32 v44, v60, v61
    v_cvt_pk_bf16_f32 v45, v62, v63
    v_cvt_pk_bf16_f32 v42, v64, v65
    v_cvt_pk_bf16_f32 v43, v66, v67
    v_cvt_pk_bf16_f32 v46, v68, v69
    v_cvt_pk_bf16_f32 v47, v70, v71
    s_nop 3
    s_branch L_backt1
L_raret2:
    s_nop 15
    v_max3_f32 v100, v16, v17, v18
    v_max3_f32 v102, v19, v24, v25
    v_max3_f32 v101, v20, v21, v22
    v_max3_f32 v103, v23, v28, v29
    v_max3_f32 v100, v100, v26, v27
    v_max3_f32 v101, v101, v30, v31
    v_max_f32 v100, v100, v102
    v_max_f32 v101, v101, v103
    v_mov_b32 v102, v100
    v_mov_b32 v103, v101
    s_nop 1
    v_permlane32_swap_b32 v100, v102
    v_permlane32_swap_b32 v101, v103
    s_nop 1
    v_max_f32 v100, v100, v102
    v_max_f32 v101, v101, v103
    v_mov_b32 v102, v100
    v_mov_b32 v103, v101
    s_nop 1
    v_permlane16_swap_b32 v100, v102
    v_permlane16_swap_b32 v101, v103
    s_nop 1
    v_max_f32 v100, v100, v102
    v_max_f32 v101, v101, v103
    v_add_f32 v100, 0x40400000, v100
    v_add_f32 v101, 0x40400000, v101
    v_max_f32 v100, 0, v100
    v_max_f32 v101, 0, v101
    v_exp_f32_e64 v104, -v100
    v_exp_f32_e64 v105, -v101
    v_sub_f32 v32, v32, v100
    v_sub_f32 v33, v33, v100
    v_sub_f32 v34, v34, v100
    v_sub_f32 v35, v35, v100
    v_sub_f32 v36, v36, v101
    v_sub_f32 v37, v37, v101
    v_sub_f32 v38, v38, v101
    v_sub_f32 v39, v39, v101
    v_sub_f32 v0, v0, v100
    v_sub_f32 v1, v1, v100
    v_sub_f32 v2, v2, v100
    v_sub_f32 v3, v3, v100
    v_sub_f32 v4, v4, v101
    v_sub_f32 v5, v5, v101
    v_sub_f32 v6, v6, v101
    v_sub_f32 v7, v7, v101
    v_sub_f32 v8, v8, v100
    v_sub_f32 v9, v9, v100
    v_sub_f32 v10, v10, v100
    v_sub_f32 v11, v11, v100
    v_sub_f32 v12, v12, v101
    v_sub_f32 v13, v13, v101
    v_sub_f32 v14, v14, v101
    v_sub_f32 v15, v15, v101
    v_sub_f32 v16, v16, v100
    v_sub_f32 v17, v17, v100
    v_sub_f32 v18, v18, v100
    v_sub_f32 v19, v19, v100
    v_sub_f32 v20, v20, v101
    v_sub_f32 v21, v21, v101
    v_sub_f32 v22, v22, v101
    v_sub_f32 v23, v23, v101
    v_sub_f32 v24, v24, v100
    v_sub_f32 v25, v25, v100
    v_sub_f32 v26, v26, v100
    v_sub_f32 v27, v27, v100
    v_sub_f32 v28, v28, v101
    v_sub_f32 v29, v29, v101
    v_sub_f32 v30, v30, v101
    v_sub_f32 v31, v31, v101
    v_mul_f32 v128, v128, v104
    v_mul_f32 v129, v129, v104
    v_mul_f32 v130, v130, v104
    v_mul_f32 v131, v131, v104
    v_mul_f32 v132, v132, v105
    v_mul_f32 v133, v133, v105
    v_mul_f32 v134, v134, v105
    v_mul_f32 v135, v135, v105
    v_mul_f32 v136, v136, v104
    v_mul_f32 v137, v137, v104
    v_mul_f32 v138, v138, v104
    v_mul_f32 v139, v139, v104
    v_mul_f32 v140, v140, v105
    v_mul_f32 v141, v141, v105
    v_mul_f32 v142, v142, v105
    v_mul_f32 v143, v143, v105
    v_mul_f32 v144, v144, v104
    v_mul_f32 v145, v145, v104
    v_mul_f32 v146, v146, v104
    v_mul_f32 v147, v147, v104
    v_mul_f32 v148, v148, v105
    v_mul_f32 v149, v149, v105
    v_mul_f32 v150, v150, v105
    v_mul_f32 v151, v151, v105
    v_mul_f32 v152, v152, v104
    v_mul_f32 v153, v153, v104
    v_mul_f32 v154, v154, v104
    v_mul_f32 v155, v155, v104
    v_mul_f32 v156, v156, v105
    v_mul_f32 v157, v157, v105
    v_mul_f32 v158, v158, v105
    v_mul_f32 v159, v159, v105
    v_mul_f32 v160, v160, v104
    v_mul_f32 v161, v161, v104
    v_mul_f32 v162, v162, v104
    v_mul_f32 v163, v163, v104
    v_mul_f32 v164, v164, v105
    v_mul_f32 v165, v165, v105
    v_mul_f32 v166, v166, v105
    v_mul_f32 v167, v167, v105
    v_mul_f32 v168, v168, v104
    v_mul_f32 v169, v169, v104
    v_mul_f32 v170, v170, v104
    v_mul_f32 v171, v171, v104
    v_mul_f32 v172, v172, v105
    v_mul_f32 v173, v173, v105
    v_mul_f32 v174, v174, v105
    v_mul_f32 v175, v175, v105
    v_mul_f32 v176, v176, v104
    v_mul_f32 v177, v177, v104
    v_mul_f32 v178, v178, v104
    v_mul_f32 v179, v179, v104
    v_mul_f32 v180, v180, v105
    v_mul_f32 v181, v181, v105
    v_mul_f32 v182, v182, v105
    v_mul_f32 v183, v183, v105
    v_mul_f32 v184, v184, v104
    v_mul_f32 v185, v185, v104
    v_mul_f32 v186, v186, v104
    v_mul_f32 v187, v187, v104
    v_mul_f32 v188, v188, v105
    v_mul_f32 v189, v189, v105
    v_mul_f32 v190, v190, v105
    v_mul_f32 v191, v191, v105
    v_mul_f32 v192, v192, v104
    v_mul_f32 v193, v193, v104
    v_mul_f32 v194, v194, v104
    v_mul_f32 v195, v195, v104
    v_mul_f32 v196, v196, v105
    v_mul_f32 v197, v197, v105
    v_mul_f32 v198, v198, v105
    v_mul_f32 v199, v199, v105
    v_mul_f32 v200, v200, v104
    v_mul_f32 v201, v201, v104
    v_mul_f32 v202, v202, v104
    v_mul_f32 v203, v203, v104
    v_mul_f32 v204, v204, v105
    v_mul_f32 v205, v205, v105
    v_mul_f32 v206, v206, v105
    v_mul_f32 v207, v207, v105
    v_mul_f32 v208, v208, v104
    v_mul_f32 v209, v209, v104
    v_mul_f32 v210, v210, v104
    v_mul_f32 v211, v211, v104
    v_mul_f32 v212, v212, v105
    v_mul_f32 v213, v213, v105
    v_mul_f32 v214, v214, v105
    v_mul_f32 v215, v215, v105
    v_mul_f32 v216, v216, v104
    v_mul_f32 v217, v217, v104
    v_mul_f32 v218, v218, v104
    v_mul_f32 v219, v219, v104
    v_mul_f32 v220, v220, v105
    v_mul_f32 v221, v221, v105
    v_mul_f32 v222, v222, v105
    v_mul_f32 v223, v223, v105
    v_mul_f32 v224, v224, v104
    v_mul_f32 v225, v225, v104
    v_mul_f32 v226, v226, v104
    v_mul_f32 v227, v227, v104
    v_mul_f32 v228, v228, v105
    v_mul_f32 v229, v229, v105
    v_mul_f32 v230, v230, v105
    v_mul_f32 v231, v231, v105
    v_mul_f32 v232, v232, v104
    v_mul_f32 v233, v233, v104
    v_mul_f32 v234, v234, v104
    v_mul_f32 v235, v235, v104
    v_mul_f32 v236, v236, v105
    v_mul_f32 v237, v237, v105
    v_mul_f32 v238, v238, v105
    v_mul_f32 v239, v239, v105
    v_mul_f32 v240, v240, v104
    v_mul_f32 v241, v241, v104
    v_mul_f32 v242, v242, v104
    v_mul_f32 v243, v243, v104
    v_mul_f32 v244, v244, v105
    v_mul_f32 v245, v245, v105
    v_mul_f32 v246, v246, v105
    v_mul_f32 v247, v247, v105
    v_mul_f32 v248, v248, v104
    v_mul_f32 v249, v249, v104
    v_mul_f32 v250, v250, v104
    v_mul_f32 v251, v251, v104
    v_mul_f32 v252, v252, v105
    v_mul_f32 v253, v253, v105
    v_mul_f32 v254, v254, v105
    v_mul_f32 v255, v255, v105
    v_mul_f32 v72, v72, v104
    v_mul_f32 v73, v73, v105
    v_exp_f32 v56, v16
    v_exp_f32 v57, v17
    v_exp_f32 v58, v18
    v_exp_f32 v59, v19
    v_exp_f32 v60, v20
    v_exp_f32 v61, v21
    v_exp_f32 v62, v22
    v_exp_f32 v63, v23
    v_exp_f32 v64, v24
    v_exp_f32 v65, v25
    v_exp_f32 v66, v26
    v_exp_f32 v67, v27
    v_exp_f32 v68, v28
    v_exp_f32 v69, v29
    v_exp_f32 v70, v30
    v_exp_f32 v71, v31
    v_add_f32 v74, v56, v57
    v_add_f32 v74, v74, v58
    v_add_f32 v74, v74, v59
    v_add_f32 v75, v60, v61
    v_add_f32 v75, v75, v62
    v_add_f32 v75, v75, v63
    v_add_f32 v74, v74, v64
    v_add_f32 v74, v74, v65
    v_add_f32 v74, v74, v66
    v_add_f32 v74, v74, v67
    v_add_f32 v75, v75, v68
    v_add_f32 v75, v75, v69
    v_add_f32 v75, v75, v70
    v_add_f32 v75, v75, v71
    v_cvt_pk_bf16_f32 v48, v56, v57
    v_cvt_pk_bf16_f32 v49, v58, v59
    v_cvt_pk_bf16_f32 v52, v60, v61
    v_cvt_pk_bf16_f32 v53, v62, v63
    v_cvt_pk_bf16_f32 v50, v64, v65
    v_cvt_pk_bf16_f32 v51, v66, v67
    v_cvt_pk_bf16_f32 v54, v68, v69
    v_cvt_pk_bf16_f32 v55, v70, v71
    s_nop 3
    s_branch L_backt2
L_raret3:
    s_nop 15
    v_max3_f32 v100, v0, v1, v2
    v_max3_f32 v102, v3, v8, v9
    v_max3_f32 v101, v4, v5, v6
    v_max3_f32 v103, v7, v12, v13
    v_max3_f32 v100, v100, v10, v11
    v_max3_f32 v101, v101, v14, v15
    v_max_f32 v100, v100, v102
    v_max_f32 v101, v101, v103
    v_mov_b32 v102, v100
    v_mov_b32 v103, v101
    s_nop 1
    v_permlane32_swap_b32 v100, v102
    v_permlane32_swap_b32 v101, v103
    s_nop 1
    v_max_f32 v100, v100, v102
    v_max_f32 v101, v101, v103
    v_mov_b32 v102, v100
    v_mov_b32 v103, v101
    s_nop 1
    v_permlane16_swap_b32 v100, v102
    v_permlane16_swap_b32 v101, v103
    s_nop 1
    v_max_f32 v100, v100, v102
    v_max_f32 v101, v101, v103
    v_add_f32 v100, 0x40400000, v100
    v_add_f32 v101, 0x40400000, v101
    v_max_f32 v100, 0, v100
    v_max_f32 v101, 0, v101
    v_exp_f32_e64 v104, -v100
    v_exp_f32_e64 v105, -v101
    v_sub_f32 v32, v32, v100
    v_sub_f32 v33, v33, v100
    v_sub_f32 v34, v34, v100
    v_sub_f32 v35, v35, v100
    v_sub_f32 v36, v36, v101
    v_sub_f32 v37, v37, v101
    v_sub_f32 v38, v38, v101
    v_sub_f32 v39, v39, v101
    v_sub_f32 v16, v16, v100
    v_sub_f32 v17, v17, v100
    v_sub_f32 v18, v18, v100
    v_sub_f32 v19, v19, v100
    v_sub_f32 v20, v20, v101
    v_sub_f32 v21, v21, v101
    v_sub_f32 v22, v22, v101
    v_sub_f32 v23, v23, v101
    v_sub_f32 v24, v24, v100
    v_sub_f32 v25, v25, v100
    v_sub_f32 v26, v26, v100
    v_sub_f32 v27, v27, v100
    v_sub_f32 v28, v28, v101
    v_sub_f32 v29, v29, v101
    v_sub_f32 v30, v30, v101
    v_sub_f32 v31, v31, v101
    v_sub_f32 v0, v0, v100
    v_sub_f32 v1, v1, v100
    v_sub_f32 v2, v2, v100
    v_sub_f32 v3, v3, v100
    v_sub_f32 v4, v4, v101
    v_sub_f32 v5, v5, v101
    v_sub_f32 v6, v6, v101
    v_sub_f32 v7, v7, v101
    v_sub_f32 v8, v8, v100
    v_sub_f32 v9, v9, v100
    v_sub_f32 v10, v10, v100
    v_sub_f32 v11, v11, v100
    v_sub_f32 v12, v12, v101
    v_sub_f32 v13, v13, v101
    v_sub_f32 v14, v14, v101
    v_sub_f32 v15, v15, v101
    v_mul_f32 v128, v128, v104
    v_mul_f32 v129, v129, v104
    v_mul_f32 v130, v130, v104
    v_mul_f32 v131, v131, v104
    v_mul_f32 v132, v132, v105
    v_mul_f32 v133, v133, v105
    v_mul_f32 v134, v134, v105
    v_mul_f32 v135, v135, v105
    v_mul_f32 v136, v136, v104
    v_mul_f32 v137, v137, v104
    v_mul_f32 v138, v138, v104
    v_mul_f32 v139, v139, v104
    v_mul_f32 v140, v140, v105
    v_mul_f32 v141, v141, v105
    v_mul_f32 v142, v142, v105
    v_mul_f32 v143, v143, v105
    v_mul_f32 v144, v144, v104
    v_mul_f32 v145, v145, v104
    v_mul_f32 v146, v146, v104
    v_mul_f32 v147, v147, v104
    v_mul_f32 v148, v148, v105
    v_mul_f32 v149, v149, v105
    v_mul_f32 v150, v150, v105
    v_mul_f32 v151, v151, v105
    v_mul_f32 v152, v152, v104
    v_mul_f32 v153, v153, v104
    v_mul_f32 v154, v154, v104
    v_mul_f32 v155, v155, v104
    v_mul_f32 v156, v156, v105
    v_mul_f32 v157, v157, v105
    v_mul_f32 v158, v158, v105
    v_mul_f32 v159, v159, v105
    v_mul_f32 v160, v160, v104
    v_mul_f32 v161, v161, v104
    v_mul_f32 v162, v162, v104
    v_mul_f32 v163, v163, v104
    v_mul_f32 v164, v164, v105
    v_mul_f32 v165, v165, v105
    v_mul_f32 v166, v166, v105
    v_mul_f32 v167, v167, v105
    v_mul_f32 v168, v168, v104
    v_mul_f32 v169, v169, v104
    v_mul_f32 v170, v170, v104
    v_mul_f32 v171, v171, v104
    v_mul_f32 v172, v172, v105
    v_mul_f32 v173, v173, v105
    v_mul_f32 v174, v174, v105
    v_mul_f32 v175, v175, v105
    v_mul_f32 v176, v176, v104
    v_mul_f32 v177, v177, v104
    v_mul_f32 v178, v178, v104
    v_mul_f32 v179, v179, v104
    v_mul_f32 v180, v180, v105
    v_mul_f32 v181, v181, v105
    v_mul_f32 v182, v182, v105
    v_mul_f32 v183, v183, v105
    v_mul_f32 v184, v184, v104
    v_mul_f32 v185, v185, v104
    v_mul_f32 v186, v186, v104
    v_mul_f32 v187, v187, v104
    v_mul_f32 v188, v188, v105
    v_mul_f32 v189, v189, v105
    v_mul_f32 v190, v190, v105
    v_mul_f32 v191, v191, v105
    v_mul_f32 v192, v192, v104
    v_mul_f32 v193, v193, v104
    v_mul_f32 v194, v194, v104
    v_mul_f32 v195, v195, v104
    v_mul_f32 v196, v196, v105
    v_mul_f32 v197, v197, v105
    v_mul_f32 v198, v198, v105
    v_mul_f32 v199, v199, v105
    v_mul_f32 v200, v200, v104
    v_mul_f32 v201, v201, v104
    v_mul_f32 v202, v202, v104
    v_mul_f32 v203, v203, v104
    v_mul_f32 v204, v204, v105
    v_mul_f32 v205, v205, v105
    v_mul_f32 v206, v206, v105
    v_mul_f32 v207, v207, v105
    v_mul_f32 v208, v208, v104
    v_mul_f32 v209, v209, v104
    v_mul_f32 v210, v210, v104
    v_mul_f32 v211, v211, v104
    v_mul_f32 v212, v212, v105
    v_mul_f32 v213, v213, v105
    v_mul_f32 v214, v214, v105
    v_mul_f32 v215, v215, v105
    v_mul_f32 v216, v216, v104
    v_mul_f32 v217, v217, v104
    v_mul_f32 v218, v218, v104
    v_mul_f32 v219, v219, v104
    v_mul_f32 v220, v220, v105
    v_mul_f32 v221, v221, v105
    v_mul_f32 v222, v222, v105
    v_mul_f32 v223, v223, v105
    v_mul_f32 v224, v224, v104
    v_mul_f32 v225, v225, v104
    v_mul_f32 v226, v226, v104
    v_mul_f32 v227, v227, v104
    v_mul_f32 v228, v228, v105
    v_mul_f32 v229, v229, v105
    v_mul_f32 v230, v230, v105
    v_mul_f32 v231, v231, v105
    v_mul_f32 v232, v232, v104
    v_mul_f32 v233, v233, v104
    v_mul_f32 v234, v234, v104
    v_mul_f32 v235, v235, v104
    v_mul_f32 v236, v236, v105
    v_mul_f32 v237, v237, v105
    v_mul_f32 v238, v238, v105
    v_mul_f32 v239, v239, v105
    v_mul_f32 v240, v240, v104
    v_mul_f32 v241, v241, v104
    v_mul_f32 v242, v242, v104
    v_mul_f32 v243, v243, v104
    v_mul_f32 v244, v244, v105
    v_mul_f32 v245, v245, v105
    v_mul_f32 v246, v246, v105
    v_mul_f32 v247, v247, v105
    v_mul_f32 v248, v248, v104
    v_mul_f32 v249, v249, v104
    v_mul_f32 v250, v250, v104
    v_mul_f32 v251, v251, v104
    v_mul_f32 v252, v252, v105
    v_mul_f32 v253, v253, v105
    v_mul_f32 v254, v254, v105
    v_mul_f32 v255, v255, v105
    v_mul_f32 v72, v72, v104
    v_mul_f32 v73, v73, v105
    v_exp_f32 v56, v0
    v_exp_f32 v57, v1
    v_exp_f32 v58, v2
    v_exp_f32 v59, v3
    v_exp_f32 v60, v4
    v_exp_f32 v61, v5
    v_exp_f32 v62, v6
    v_exp_f32 v63, v7
    v_exp_f32 v64, v8
    v_exp_f32 v65, v9
    v_exp_f32 v66, v10
    v_exp_f32 v67, v11
    v_exp_f32 v68, v12
    v_exp_f32 v69, v13
    v_exp_f32 v70, v14
    v_exp_f32 v71, v15
    v_add_f32 v74, v56, v57
    v_add_f32 v74, v74, v58
    v_add_f32 v74, v74, v59
    v_add_f32 v75, v60, v61
    v_add_f32 v75, v75, v62
    v_add_f32 v75, v75, v63
    v_add_f32 v74, v74, v64
    v_add_f32 v74, v74, v65
    v_add_f32 v74, v74, v66
    v_add_f32 v74, v74, v67
    v_add_f32 v75, v75, v68
    v_add_f32 v75, v75, v69
    v_add_f32 v75, v75, v70
    v_add_f32 v75, v75, v71
    v_cvt_pk_bf16_f32 v40, v56, v57
    v_cvt_pk_bf16_f32 v41, v58, v59
    v_cvt_pk_bf16_f32 v44, v60, v61
    v_cvt_pk_bf16_f32 v45, v62, v63
    v_cvt_pk_bf16_f32 v42, v64, v65
    v_cvt_pk_bf16_f32 v43, v66, v67
    v_cvt_pk_bf16_f32 v46, v68, v69
    v_cvt_pk_bf16_f32 v47, v70, v71
    s_nop 3
    s_branch L_backt3
.section .rodata,"a"
.p2align 6
.amdhsa_kernel standalone__paged_block_table_kv_pagedattention__prompt_kernel
  .amdhsa_next_free_vgpr 448
  .amdhsa_next_free_sgpr 102
  .amdhsa_accum_offset 256
  .amdhsa_group_segment_fixed_size 0
  .amdhsa_kernarg_size 64
  .amdhsa_user_sgpr_count 2
  .amdhsa_user_sgpr_kernarg_segment_ptr 1
  .amdhsa_system_sgpr_workgroup_id_x 1
.end_amdhsa_kernel
```
